```python
import torch

def _softmax(x, axis=-1):
    return torch.softmax(x, dim=axis)
def _gelu(x):
    return torch.nn.functional.gelu(x, approximate="tanh")
def _silu(x):
    return torch.nn.functional.silu(x)
def _sigmoid(x):
    return torch.sigmoid(x)
def _layernorm(x, axis=-1, eps=1e-5):
    m = x.mean(dim=axis, keepdim=True)
    v = x.var(dim=axis, keepdim=True, unbiased=False)
    return (x - m) / torch.sqrt(v + eps)
def _scatter_add(tgt, idx, src, axis=0):
    return tgt.clone().index_add_(axis, idx, src)
def _segment_sum(src, seg, n):
    out = torch.zeros((n,) + src.shape[1:], dtype=src.dtype)
    return out.index_add_(0, seg, src)
def _pad(x, pw):
    flat = tuple(v for pair in reversed(pw) for v in pair)
    return torch.nn.functional.pad(x, flat)

kernel_name = 'recurrent_scan__ssm_conv_s5__swiglu_ffn__prompt'

def setup_inputs():

    _w = (lambda a: (lambda t: t.to(torch.bfloat16) if t.is_floating_point() else t)(torch.as_tensor(a)))
    def _A_setup():
        B, S, D = 1, 2048, 448
        P = D
        Lambda_re = -0.5 * (lambda _x: torch.exp(torch.as_tensor(_x)))((lambda *s: torch.randn(*s, dtype=torch.bfloat16) * 0.2)(P))
        Lambda_im = (lambda *s: torch.randn(*s, dtype=torch.bfloat16) * 0.4)(P) * 1.0
        B_re = (lambda *s: torch.randn(*s, dtype=torch.bfloat16) * 0.2)(P, D) * (D ** -0.5)
        B_im = (lambda *s: torch.randn(*s, dtype=torch.bfloat16) * 0.2)(P, D) * (D ** -0.5)
        C_re = (lambda *s: torch.randn(*s, dtype=torch.bfloat16) * 0.2)(D, P) * (P ** -0.5)
        C_im = (lambda *s: torch.randn(*s, dtype=torch.bfloat16) * 0.2)(D, P) * (P ** -0.5)
        log_dt = (lambda *s: torch.randn(*s, dtype=torch.bfloat16) * 0.2)(P) * 0.3 - 2.0
        Dskip = (lambda *s: torch.randn(*s, dtype=torch.bfloat16) * 0.05)(D)
        return {
            "x": _w((lambda *s: torch.randn(*s, dtype=torch.bfloat16) * 0.05)(B, S, D)),
            "Lambda_re": _w(Lambda_re),
            "Lambda_im": _w(Lambda_im),
            "B_re": _w(B_re),
            "B_im": _w(B_im),
            "C_re": _w(C_re),
            "C_im": _w(C_im),
            "log_dt": _w(log_dt),
            "Dskip": _w(Dskip),
        }
    _A_in = _A_setup()

    def _B_setup():
        B, S, D, F = 1, 2048, 448, 1792
        return {
            "x": _w((lambda *s: torch.randn(*s, dtype=torch.bfloat16) * 0.05)(B, S, D)),
            "w_gate": _w((lambda *s: torch.randn(*s, dtype=torch.bfloat16) * 0.05)(D, F)),
            "w_up": _w((lambda *s: torch.randn(*s, dtype=torch.bfloat16) * 0.05)(D, F)),
            "w_down": _w((lambda *s: torch.randn(*s, dtype=torch.bfloat16) * 0.05)(F, D)),
        }
    _B_in = _B_setup()

    return {
        "A_x": _A_in["x"],
        "A_Lambda_re": _A_in["Lambda_re"],
        "A_Lambda_im": _A_in["Lambda_im"],
        "A_B_re": _A_in["B_re"],
        "A_B_im": _A_in["B_im"],
        "A_C_re": _A_in["C_re"],
        "A_C_im": _A_in["C_im"],
        "A_log_dt": _A_in["log_dt"],
        "A_Dskip": _A_in["Dskip"],
        "B_x": _B_in["x"],
        "B_w_gate": _B_in["w_gate"],
        "B_w_up": _B_in["w_up"],
        "B_w_down": _B_in["w_down"],
    }

def reference(A_x, A_Lambda_re, A_Lambda_im, A_B_re, A_B_im, A_C_re, A_C_im, A_log_dt, A_Dskip, B_x, B_w_gate, B_w_up, B_w_down):
    def _A_ref(x, Lambda_re, Lambda_im, B_re, B_im, C_re, C_im, log_dt, Dskip):
        Bsz, L, H = x.shape
        Lam = Lambda_re + 1j * Lambda_im
        Bmat = B_re + 1j * B_im
        Cmat = C_re + 1j * C_im
        dt = torch.exp(log_dt)
        Lam_bar = torch.exp(dt * Lam)
        B_bar = ((Lam_bar - 1.0) / Lam)[:, None] * Bmat
        Bu = torch.einsum("bld,pd->blp", x + 0j, B_bar)
        h = torch.zeros_like(Bu[:, 0, :])
        hs = []
        for t in range(L):
            h = Lam_bar[None, :] * h + Bu[:, t, :]
            hs.append(h)
        hseq = torch.stack(hs, 1)
        y = 2.0 * torch.einsum("blp,dp->bld", hseq, Cmat).real + x * Dskip[None, None, :]
        return y

    def _B_ref(x, w_gate, w_up, w_down):
        g = _silu(x @ w_gate)
        u = x @ w_up
        return (g * u) @ w_down

    x = A_x
    xn = _layernorm(x, axis=-1)
    s = _A_ref(xn, A_Lambda_re, A_Lambda_im, A_B_re, A_B_im, A_C_re, A_C_im, A_log_dt, A_Dskip)
    g = _silu(_B_ref(xn, B_w_gate, B_w_up, B_w_down))
    return x + s * g
```

```asm
; @launch grid=(256,1,1) block=(512,1,1) lds=163840
.amdgcn_target "amdgcn-amd-amdhsa--gfx950"
.text
.globl recurrent_scan__ssm_conv_s5__swiglu_ffn__prompt_kernel
.p2align 8
.type recurrent_scan__ssm_conv_s5__swiglu_ffn__prompt_kernel,@function
recurrent_scan__ssm_conv_s5__swiglu_ffn__prompt_kernel:
    s_cmp_ge_u32 s2, 256
    s_cbranch_scc1 L_END
    s_load_dwordx2 s[16:17], s[0:1], 0
    s_mov_b32 s18, 1835008
    s_mov_b32 s19, 0x20000
    s_load_dwordx2 s[20:21], s[0:1], 80
    s_mov_b32 s22, 1605632
    s_mov_b32 s23, 0x20000
    s_load_dwordx2 s[24:25], s[0:1], 88
    s_mov_b32 s26, 1605632
    s_mov_b32 s27, 0x20000
    s_load_dwordx2 s[28:29], s[0:1], 24
    s_mov_b32 s30, 401408
    s_mov_b32 s31, 0x20000
    s_load_dwordx2 s[32:33], s[0:1], 32
    s_mov_b32 s34, 401408
    s_mov_b32 s35, 0x20000
    s_load_dwordx2 s[36:37], s[0:1], 120
    s_mov_b32 s38, 16777216
    s_mov_b32 s39, 0x20000
    s_load_dwordx2 s[56:57], s[0:1], 112
    s_mov_b32 s58, 256
    s_mov_b32 s59, 0x20000
    s_load_dwordx2 s[40:41], s[0:1], 96
    s_mov_b32 s42, 1605632
    s_mov_b32 s43, 0x20000
    s_load_dwordx2 s[44:45], s[0:1], 40
    s_mov_b32 s46, 401408
    s_mov_b32 s47, 0x20000
    s_load_dwordx2 s[48:49], s[0:1], 48
    s_mov_b32 s50, 401408
    s_mov_b32 s51, 0x20000
    s_load_dwordx2 s[52:53], s[0:1], 104
    s_mov_b32 s54, 3670016
    s_mov_b32 s55, 0x20000
    s_load_dwordx4 s[60:63], s[0:1], 8
    s_load_dwordx4 s[64:67], s[0:1], 56
    s_memrealtime s[86:87]
    s_getpc_b64 s[90:91]
L_PC:
    s_lshr_b32 s5, s2, 3
    s_lshl_b32 s72, s5, 11
    v_lshlrev_b32 v5, 2, v0
    v_add_u32 v5, s72, v5
    s_mov_b32 s73, L_CODE_END-L_PC-4
    v_min_u32 v5, s73, v5
    v_and_b32 v5, 0xfffffffc, v5
    v_lshrrev_b32 v2, 6, v0
    v_and_b32 v1, 63, v0
    global_load_dword a63, v5, s[90:91]
    s_and_b32 s4, s2, 7
    v_readfirstlane_b32 s10, v2
    v_lshrrev_b32 v3, 3, v1
    v_and_b32 v4, 7, v1
    s_and_b32 s11, s10, 3
    s_lshr_b32 s12, s10, 2
    s_cmp_ge_u32 s5, 28
    s_cbranch_scc1 L_HELPER
    s_lshr_b32 s72, s4, 1
    s_and_b32 s73, s4, 1
    s_and_b32 s74, s5, 3
    s_lshr_b32 s9, s5, 2
    s_lshl_b32 s6, s72, 2
    s_add_u32 s6, s6, s74
    s_mul_i32 s7, s73, 7
    s_add_u32 s7, s7, s9
    s_lshl_b32 s8, s4, 2
    s_add_u32 s8, s8, s74
    v_lshlrev_b32 v2, 4, v1
    v_and_b32 v5, 31, v1
    v_lshrrev_b32 v6, 5, v1
    s_mov_b32 s80, 0
    s_mov_b32 s81, -1
    s_cmp_eq_u32 s12, 0
    s_cbranch_scc1 L_COMPUTE
    s_lshl_b32 s74, s74, 1
    s_add_u32 s74, s74, s9
    s_mul_i32 s75, s74, 43
    s_lshr_b32 s75, s75, 8
    s_mul_i32 s75, s75, 6
    s_sub_u32 s75, s74, s75
    s_lshl_b32 s75, s75, 2
    s_mov_b32 s72, 0x21654321
    s_mov_b32 s73, 0x00006543
    s_lshr_b64 s[72:73], s[72:73], s75
    s_lshl_b32 s101, s72, 4
    s_sub_u32 s75, s74, 7
    s_cmp_ge_u32 s74, 7
    s_cselect_b32 s74, s75, s74
    s_lshl_b32 s74, s74, 2
    s_mov_b32 s72, 0x06543210
    s_mov_b32 s73, 0x00654321
    s_lshr_b64 s[72:73], s[72:73], s74
    s_mov_b32 s100, s72
    s_mov_b32 s101, s101
    v_lshrrev_b32 v44, 1, v3
    v_xor_b32 v44, v4, v44
    s_lshl_b32 s72, s11, 5
    v_add_u32 v45, s72, v3
    v_mul_u32_u24 v45, 896, v45
    v_lshl_add_u32 v8, v44, 4, v45
    v_xor_b32 v9, 64, v8
    v_add_u32 v9, 7168, v9
    v_add_u32 v10, 14336, v8
    v_add_u32 v11, 14336, v9
    v_bfe_u32 v46, v3, 1, 1
    v_lshlrev_b32 v46, 1, v46
    v_xor_b32 v46, v4, v46
    s_lshl_b32 s72, s11, 4
    v_add_u32 v45, s72, v3
    v_mul_u32_u24 v45, 3584, v45
    v_lshl_add_u32 v12, v46, 4, v45
    v_add_u32 v13, 28672, v12
    v_xor_b32 v16, 64, v12
    v_xor_b32 v17, 64, v13
    s_lshr_b32 s73, s11, 1
    v_xor_b32 v44, s73, v44
    s_and_b32 s72, s11, 1
    s_lshl_b32 s72, s72, 4
    v_add_u32 v45, s72, v3
    v_mul_u32_u24 v45, 896, v45
    v_lshl_add_u32 v20, v44, 4, v45
    v_xor_b32 v21, 64, v20
    v_add_u32 v21, 7168, v21
    s_mul_i32 s68, s6, 114688
    s_lshl_b32 s69, s7, 8
    s_mul_i32 s70, s7, 28672
    s_lshl_b32 s13, s11, 12
    s_lshl_b32 s2, s11, 11
    s_lshl_b32 s72, s73, 4
    v_bfe_u32 v48, v1, 1, 4
    v_add_u32 v48, s72, v48
    s_lshl_b32 s72, s7, 5
    v_add_u32 v48, s72, v48
    v_lshlrev_b32 v48, 1, v48
    s_cmp_eq_u32 s73, 0
    s_waitcnt lgkmcnt(0)
    s_cselect_b32 s92, s28, s32
    s_cselect_b32 s93, s29, s33
    s_mov_b32 s94, 401408
    s_mov_b32 s95, 0x20000
    global_load_ushort v49, v48, s[60:61]
    global_load_ushort v50, v48, s[62:63]
    global_load_ushort v51, v48, s[64:65]
    s_bfe_u32 s5, s101, 262144
    s_lshl_b32 s5, s5, 7
    s_add_u32 s5, s5, s70
    s_add_u32 m0, s2, 147456
    s_nop 0
    buffer_load_dwordx4 v20, s[92:95], s5 offen lds
    s_add_u32 m0, s2, 148480
    s_nop 0
    buffer_load_dwordx4 v21, s[92:95], s5 offen lds
    s_bfe_u32 s99, s101, 262144
    s_lshl_b32 s4, s99, 7
    s_add_u32 s4, s4, s68
    s_mul_i32 s99, s99, 229376
    s_add_u32 s99, s99, s69
    s_add_u32 m0, s13, 16384
    s_nop 0
    buffer_load_dwordx4 v8, s[16:19], s4 offen lds
    s_add_u32 m0, s13, 17408
    s_nop 0
    buffer_load_dwordx4 v9, s[16:19], s4 offen lds
    s_add_u32 m0, s13, 18432
    s_nop 0
    buffer_load_dwordx4 v10, s[16:19], s4 offen lds
    s_add_u32 m0, s13, 19456
    s_nop 0
    buffer_load_dwordx4 v11, s[16:19], s4 offen lds
    s_add_u32 m0, s2, 32768
    s_nop 0
    buffer_load_dwordx4 v12, s[20:23], s99 offen lds
    s_add_u32 m0, s2, 33792
    s_nop 0
    buffer_load_dwordx4 v13, s[20:23], s99 offen lds
    s_add_u32 m0, s2, 40960
    s_nop 0
    buffer_load_dwordx4 v16, s[24:27], s99 offen lds
    s_add_u32 m0, s2, 41984
    s_nop 0
    buffer_load_dwordx4 v17, s[24:27], s99 offen lds
    s_bfe_u32 s5, s101, 262148
    s_lshl_b32 s5, s5, 7
    s_add_u32 s5, s5, s70
    s_add_u32 m0, s2, 155648
    s_nop 0
    buffer_load_dwordx4 v20, s[92:95], s5 offen lds
    s_add_u32 m0, s2, 156672
    s_nop 0
    buffer_load_dwordx4 v21, s[92:95], s5 offen lds
    s_bfe_u32 s99, s101, 262148
    s_lshl_b32 s4, s99, 7
    s_add_u32 s4, s4, s68
    s_mul_i32 s99, s99, 229376
    s_add_u32 s99, s99, s69
    s_add_u32 m0, s13, 49152
    s_nop 0
    buffer_load_dwordx4 v8, s[16:19], s4 offen lds
    s_add_u32 m0, s13, 50176
    s_nop 0
    buffer_load_dwordx4 v9, s[16:19], s4 offen lds
    s_add_u32 m0, s13, 51200
    s_nop 0
    buffer_load_dwordx4 v10, s[16:19], s4 offen lds
    s_add_u32 m0, s13, 52224
    s_nop 0
    buffer_load_dwordx4 v11, s[16:19], s4 offen lds
    s_add_u32 m0, s2, 65536
    s_nop 0
    buffer_load_dwordx4 v12, s[20:23], s99 offen lds
    s_add_u32 m0, s2, 66560
    s_nop 0
    buffer_load_dwordx4 v13, s[20:23], s99 offen lds
    s_add_u32 m0, s2, 73728
    s_nop 0
    buffer_load_dwordx4 v16, s[24:27], s99 offen lds
    s_add_u32 m0, s2, 74752
    s_nop 0
    buffer_load_dwordx4 v17, s[24:27], s99 offen lds
    s_waitcnt vmcnt(10)
    s_barrier
    s_bfe_u32 s99, s101, 262152
    s_lshl_b32 s4, s99, 7
    s_add_u32 s4, s4, s68
    s_mul_i32 s99, s99, 229376
    s_add_u32 s99, s99, s69
    s_add_u32 m0, s13, 81920
    s_nop 0
    buffer_load_dwordx4 v8, s[16:19], s4 offen lds
    v_and_b32 v44, 3, v1
    v_bfe_u32 v45, v1, 2, 1
    v_bfe_u32 v46, v1, 3, 2
    v_lshl_or_b32 v44, v45, 4, v44
    v_lshl_or_b32 v44, v46, 2, v44
    s_lshl_b32 s72, s11, 5
    v_add_u32 v57, s72, v44
    v_lshlrev_b32 v55, 4, v57
    v_lshlrev_b32 v57, 2, v57
    s_add_u32 m0, s13, 82944
    s_nop 0
    buffer_load_dwordx4 v9, s[16:19], s4 offen lds
    v_lshlrev_b32 v58, 4, v5
    v_mov_b32 v56, 0
    s_lshl_b32 s60, s6, 11
    s_add_u32 s60, s60, 11534336
    s_mul_i32 s61, s7, 10240
    s_add_u32 s61, s61, 11599872
    s_and_b32 s72, s11, 1
    s_lshl_b32 s72, s72, 10
    s_add_u32 s62, s61, s72
    s_add_u32 s62, s62, 8192
    s_lshl_b32 s72, s11, 10
    s_add_u32 s61, s61, s72
    s_add_u32 s63, s61, 4096
    s_mul_i32 s72, s6, 1792
    s_lshl_b32 s73, s7, 3
    s_add_u32 s72, s72, s73
    s_add_u32 s89, s72, 12058624
    s_lshl_b32 s72, s7, 1
    s_lshr_b32 s73, s11, 1
    s_add_u32 s72, s72, s73
    s_lshl_b32 s72, s72, 4
    s_add_u32 s72, s72, s6
    s_lshl_b32 s72, s72, 9
    s_add_u32 s90, s72, 11796480
    s_sub_u32 s91, s90, 12288
    v_lshlrev_b32 v49, 16, v49
    v_lshlrev_b32 v50, 16, v50
    v_lshlrev_b32 v51, 16, v51
    v_mul_f32 v51, 1.4426950408889634, v51
    v_exp_f32 v51, v51
    v_and_b32 v54, 1, v1
    s_add_u32 m0, s13, 83968
    s_nop 0
    buffer_load_dwordx4 v10, s[16:19], s4 offen lds
    v_cvt_f32_u32 v54, v54
    v_cvt_pk_bf16_f32 v51, v51, v51
    v_and_b32 v51, 0xffff0000, v51
    v_mul_f32 v52, v51, v49
    v_mul_f32 v53, v51, v50
    v_mul_f32 v52, 1.4426950408889634, v52
    v_mul_f32 v53, 0.15915494309189535, v53
    v_fma_f32 v54, v54, 2.0, -1.0
    s_add_u32 m0, s13, 84992
    s_nop 0
    buffer_load_dwordx4 v11, s[16:19], s4 offen lds
    v_mul_f32 v44, 1.0, v52
    v_mul_f32 v45, 1.0, v53
    v_exp_f32 v44, v44
    v_fract_f32 v45, v45
    s_nop 0
    v_cos_f32 v32, v45
    v_sin_f32 v33, v45
    s_nop 0
    v_mul_f32 v32, v32, v44
    v_mul_f32 v33, v33, v44
    s_add_u32 m0, s2, 98304
    s_nop 0
    buffer_load_dwordx4 v12, s[20:23], s99 offen lds
    v_add_f32 v44, -1.0, v32
    v_mul_f32 v45, v49, v49
    v_fmac_f32 v45, v50, v50
    v_rcp_f32 v45, v45
    v_mul_f32 v46, v44, v49
    v_fmac_f32 v46, v33, v50
    v_mul_f32 v47, v33, v49
    v_fma_f32 v47, -v44, v50, v47
    s_add_u32 m0, s2, 99328
    s_nop 0
    buffer_load_dwordx4 v13, s[20:23], s99 offen lds
    v_mul_f32 v46, v46, v45
    v_mul_f32 v47, v47, v45
    v_mul_f32 v46, -2.0, v46
    v_mul_f32 v40, v46, v54
    v_mul_f32 v41, -2.0, v47
    v_mul_f32 v33, v33, v54
    v_mov_b32 v48, 0x41800000
    v_mul_f32 v44, v48, v52
    s_add_u32 m0, s2, 106496
    s_nop 0
    buffer_load_dwordx4 v16, s[24:27], s99 offen lds
    v_mul_f32 v45, v48, v53
    v_exp_f32 v44, v44
    v_fract_f32 v45, v45
    s_nop 0
    v_cos_f32 v34, v45
    v_sin_f32 v35, v45
    s_nop 0
    v_mul_f32 v34, v34, v44
    v_mul_f32 v35, v35, v44
    v_mul_f32 v35, v35, v54
    s_add_u32 m0, s2, 107520
    s_nop 0
    buffer_load_dwordx4 v17, s[24:27], s99 offen lds
    v_mov_b32 v48, 0x43000000
    v_mul_f32 v44, v48, v52
    v_mul_f32 v45, v48, v53
    v_exp_f32 v44, v44
    v_fract_f32 v45, v45
    s_nop 0
    v_cos_f32 v36, v45
    v_sin_f32 v37, v45
    s_nop 0
    v_mul_f32 v36, v36, v44
    s_bfe_u32 s99, s101, 262156
    s_lshl_b32 s4, s99, 7
    s_add_u32 s4, s4, s68
    s_mul_i32 s99, s99, 229376
    s_add_u32 s99, s99, s69
    s_add_u32 m0, s13, 114688
    s_nop 0
    buffer_load_dwordx4 v8, s[16:19], s4 offen lds
    v_mul_f32 v37, v37, v44
    v_mul_f32 v37, v37, v54
    v_mov_b32 v48, 0x44800000
    v_mul_f32 v44, v48, v52
    v_mul_f32 v45, v48, v53
    v_exp_f32 v44, v44
    v_fract_f32 v45, v45
    s_nop 0
    v_cos_f32 v38, v45
    s_add_u32 m0, s13, 115712
    s_nop 0
    buffer_load_dwordx4 v9, s[16:19], s4 offen lds
    v_sin_f32 v39, v45
    s_nop 0
    v_mul_f32 v38, v38, v44
    v_mul_f32 v39, v39, v44
    v_mul_f32 v39, v39, v54
    s_lshr_b32 s73, s11, 1
    s_lshl_b32 s73, s73, 9
    v_lshl_add_u32 v47, v5, 2, s73
    ds_write_b32 v47, v32 offset:8192
    ds_write_b32 v47, v33 offset:8320
    ds_write_b32 v47, v40 offset:8448
    s_add_u32 m0, s13, 116736
    s_nop 0
    buffer_load_dwordx4 v10, s[16:19], s4 offen lds
    ds_write_b32 v47, v41 offset:8576
    v_bfe_u32 v44, v3, 1, 1
    v_lshlrev_b32 v44, 2, v44
    v_xor_b32 v44, v4, v44
    v_mul_u32_u24 v45, 896, v3
    v_lshl_add_u32 v22, v44, 4, v45
    v_add_u32 v23, 7168, v22
    v_lshrrev_b32 v44, 1, v3
    s_add_u32 m0, s13, 117760
    s_nop 0
    buffer_load_dwordx4 v11, s[16:19], s4 offen lds
    v_xor_b32 v44, v4, v44
    v_lshl_add_u32 v24, v44, 4, v45
    v_xor_b32 v25, 64, v24
    v_add_u32 v25, 7168, v25
    v_min_u32 v7, 13, v1
    v_lshlrev_b32 v7, 3, v7
    s_lshr_b32 s73, s11, 1
    s_and_b32 s74, s11, 1
    s_lshl_b32 s72, s8, 1
    s_add_u32 s72, s72, s73
    s_mul_i32 s72, s72, 172032
    s_lshl_b32 s76, s74, 12
    s_add_u32 s84, s72, s76
    s_add_u32 s85, s84, 114688
    s_lshl_b32 s76, s74, 13
    s_add_u32 s82, s72, s76
    s_lshl_b32 s76, s73, 7
    s_lshl_b32 s77, s74, 5
    s_add_u32 s76, s76, s77
    s_mul_i32 s83, s76, 896
    s_lshl_b32 s75, s9, 7
    s_add_u32 s83, s83, s75
    s_lshl_b32 s76, s9, 6
    s_lshl_b32 s77, s74, 5
    s_add_u32 s76, s76, s77
    s_mul_i32 s87, s76, 896
    s_mul_i32 s3, s8, 7
    s_add_u32 s3, s3, s9
    s_lshl_b32 s3, s3, 7
    s_add_u32 s3, s3, 12058624
    s_cmp_eq_u32 s73, 0
    s_cselect_b32 s28, s44, s48
    s_cselect_b32 s29, s45, s49
    s_mov_b32 s30, 401408
    s_mov_b32 s31, 0x20000
    v_lshlrev_b32 v59, 3, v6
    v_sub_u32 v59, s6, v59
    s_add_u32 m0, s2, 131072
    s_nop 0
    buffer_load_dwordx4 v12, s[20:23], s99 offen lds
    v_add_u32 v59, -1, v59
    v_lshlrev_b32 v60, 12, v6
    v_sub_u32 v60, v58, v60
    v_add_u32 v60, 8192, v60
    s_lshr_b32 s73, s11, 1
    s_lshl_b32 s73, s73, 10
    v_lshl_add_u32 v61, v5, 5, s73
    v_lshl_add_u32 v62, v5, 2, s73
    s_add_u32 m0, s2, 132096
    s_nop 0
    buffer_load_dwordx4 v13, s[20:23], s99 offen lds
    s_add_u32 m0, s2, 139264
    s_nop 0
    buffer_load_dwordx4 v16, s[24:27], s99 offen lds
    s_add_u32 m0, s2, 140288
    s_nop 0
    buffer_load_dwordx4 v17, s[24:27], s99 offen lds
    s_waitcnt vmcnt(16)
    s_barrier
    s_bfe_u32 s5, s101, 262152
    s_lshl_b32 s5, s5, 7
    s_add_u32 s5, s5, s70
    s_add_u32 m0, s2, 147456
    s_nop 0
    buffer_load_dwordx4 v20, s[92:95], s5 offen lds
    s_add_u32 m0, s2, 148480
    s_nop 0
    buffer_load_dwordx4 v21, s[92:95], s5 offen lds
    s_bfe_u32 s99, s101, 262160
    s_lshl_b32 s4, s99, 7
    s_add_u32 s4, s4, s68
    s_mul_i32 s99, s99, 229376
    s_add_u32 s99, s99, s69
    s_add_u32 m0, s13, 16384
    s_nop 0
    buffer_load_dwordx4 v8, s[16:19], s4 offen lds
    s_add_u32 m0, s13, 17408
    s_nop 0
    buffer_load_dwordx4 v9, s[16:19], s4 offen lds
    s_add_u32 m0, s13, 18432
    s_nop 0
    buffer_load_dwordx4 v10, s[16:19], s4 offen lds
    s_add_u32 m0, s13, 19456
    s_nop 0
    buffer_load_dwordx4 v11, s[16:19], s4 offen lds
    s_add_u32 m0, s2, 32768
    s_nop 0
    buffer_load_dwordx4 v12, s[20:23], s99 offen lds
    s_add_u32 m0, s2, 33792
    s_nop 0
    buffer_load_dwordx4 v13, s[20:23], s99 offen lds
    s_add_u32 m0, s2, 40960
    s_nop 0
    buffer_load_dwordx4 v16, s[24:27], s99 offen lds
    s_add_u32 m0, s2, 41984
    s_nop 0
    buffer_load_dwordx4 v17, s[24:27], s99 offen lds
    s_waitcnt vmcnt(8)
    s_barrier
    s_bfe_u32 s5, s101, 262156
    s_lshl_b32 s5, s5, 7
    s_add_u32 s5, s5, s70
    s_add_u32 m0, s2, 155648
    s_nop 0
    buffer_load_dwordx4 v20, s[92:95], s5 offen lds
    s_add_u32 m0, s2, 156672
    s_nop 0
    buffer_load_dwordx4 v21, s[92:95], s5 offen lds
    s_bfe_u32 s99, s101, 262164
    s_lshl_b32 s4, s99, 7
    s_add_u32 s4, s4, s68
    s_mul_i32 s99, s99, 229376
    s_add_u32 s99, s99, s69
    s_add_u32 m0, s13, 49152
    s_nop 0
    buffer_load_dwordx4 v8, s[16:19], s4 offen lds
    s_add_u32 m0, s13, 50176
    s_nop 0
    buffer_load_dwordx4 v9, s[16:19], s4 offen lds
    s_add_u32 m0, s13, 51200
    s_nop 0
    buffer_load_dwordx4 v10, s[16:19], s4 offen lds
    s_add_u32 m0, s13, 52224
    s_nop 0
    buffer_load_dwordx4 v11, s[16:19], s4 offen lds
    s_add_u32 m0, s2, 65536
    s_nop 0
    buffer_load_dwordx4 v12, s[20:23], s99 offen lds
    s_add_u32 m0, s2, 66560
    s_nop 0
    buffer_load_dwordx4 v13, s[20:23], s99 offen lds
    s_add_u32 m0, s2, 73728
    s_nop 0
    buffer_load_dwordx4 v16, s[24:27], s99 offen lds
    s_add_u32 m0, s2, 74752
    s_nop 0
    buffer_load_dwordx4 v17, s[24:27], s99 offen lds
    s_waitcnt vmcnt(8)
    s_barrier
    s_bfe_u32 s5, s101, 262160
    s_lshl_b32 s5, s5, 7
    s_add_u32 s5, s5, s70
    s_add_u32 m0, s2, 147456
    s_nop 0
    buffer_load_dwordx4 v20, s[92:95], s5 offen lds
    s_add_u32 m0, s2, 148480
    s_nop 0
    buffer_load_dwordx4 v21, s[92:95], s5 offen lds
    s_bfe_u32 s99, s101, 262168
    s_lshl_b32 s4, s99, 7
    s_add_u32 s4, s4, s68
    s_mul_i32 s99, s99, 229376
    s_add_u32 s99, s99, s69
    s_add_u32 m0, s13, 81920
    s_nop 0
    buffer_load_dwordx4 v8, s[16:19], s4 offen lds
    s_add_u32 m0, s13, 82944
    s_nop 0
    buffer_load_dwordx4 v9, s[16:19], s4 offen lds
    s_add_u32 m0, s13, 83968
    s_nop 0
    buffer_load_dwordx4 v10, s[16:19], s4 offen lds
    s_add_u32 m0, s13, 84992
    s_nop 0
    buffer_load_dwordx4 v11, s[16:19], s4 offen lds
    s_add_u32 m0, s2, 98304
    s_nop 0
    buffer_load_dwordx4 v12, s[20:23], s99 offen lds
    s_add_u32 m0, s2, 99328
    s_nop 0
    buffer_load_dwordx4 v13, s[20:23], s99 offen lds
    s_add_u32 m0, s2, 106496
    s_nop 0
    buffer_load_dwordx4 v16, s[24:27], s99 offen lds
    s_add_u32 m0, s2, 107520
    s_nop 0
    buffer_load_dwordx4 v17, s[24:27], s99 offen lds
    s_waitcnt vmcnt(8)
    s_barrier
    s_bfe_u32 s5, s101, 262164
    s_lshl_b32 s5, s5, 7
    s_add_u32 s5, s5, s70
    s_add_u32 m0, s2, 155648
    s_nop 0
    buffer_load_dwordx4 v20, s[92:95], s5 offen lds
    s_add_u32 m0, s2, 156672
    s_nop 0
    buffer_load_dwordx4 v21, s[92:95], s5 offen lds
    s_bfe_u32 s99, s101, 262144
    s_lshl_b32 s4, s99, 7
    s_add_u32 s4, s4, s68
    s_mul_i32 s99, s99, 229376
    s_add_u32 s99, s99, s69
    s_add_u32 s99, s99, 128
    s_add_u32 m0, s13, 114688
    s_nop 0
    buffer_load_dwordx4 v8, s[16:19], s4 offen lds
    s_add_u32 m0, s13, 115712
    s_nop 0
    buffer_load_dwordx4 v9, s[16:19], s4 offen lds
    s_add_u32 m0, s13, 116736
    s_nop 0
    buffer_load_dwordx4 v10, s[16:19], s4 offen lds
    s_add_u32 m0, s13, 117760
    s_nop 0
    buffer_load_dwordx4 v11, s[16:19], s4 offen lds
    s_add_u32 m0, s2, 131072
    s_nop 0
    buffer_load_dwordx4 v12, s[20:23], s99 offen lds
    s_add_u32 m0, s2, 132096
    s_nop 0
    buffer_load_dwordx4 v13, s[20:23], s99 offen lds
    s_add_u32 m0, s2, 139264
    s_nop 0
    buffer_load_dwordx4 v16, s[24:27], s99 offen lds
    s_add_u32 m0, s2, 140288
    s_nop 0
    buffer_load_dwordx4 v17, s[24:27], s99 offen lds
    buffer_load_dwordx2 v[26:27], v56, s[56:59], 0 offen sc1
    buffer_load_dwordx4 v[64:67], v55, s[36:39], s60 offen sc1
    buffer_load_dwordx4 v[68:71], v2, s[36:39], s61 offen sc1
    buffer_load_dwordx4 v[76:79], v58, s[36:39], s62 offen sc1
    s_waitcnt vmcnt(12)
    s_barrier
    s_bfe_u32 s5, s101, 262168
    s_lshl_b32 s5, s5, 7
    s_add_u32 s5, s5, s70
    s_add_u32 m0, s2, 147456
    s_nop 0
    buffer_load_dwordx4 v20, s[92:95], s5 offen lds
    s_add_u32 m0, s2, 148480
    s_nop 0
    buffer_load_dwordx4 v21, s[92:95], s5 offen lds
    s_bfe_u32 s99, s101, 262148
    s_lshl_b32 s4, s99, 7
    s_add_u32 s4, s4, s68
    s_mul_i32 s99, s99, 229376
    s_add_u32 s99, s99, s69
    s_add_u32 s99, s99, 128
    s_add_u32 m0, s13, 16384
    s_nop 0
    buffer_load_dwordx4 v8, s[16:19], s4 offen lds
    s_add_u32 m0, s13, 17408
    s_nop 0
    buffer_load_dwordx4 v9, s[16:19], s4 offen lds
    s_add_u32 m0, s13, 18432
    s_nop 0
    buffer_load_dwordx4 v10, s[16:19], s4 offen lds
    s_add_u32 m0, s13, 19456
    s_nop 0
    buffer_load_dwordx4 v11, s[16:19], s4 offen lds
    s_add_u32 m0, s2, 32768
    s_nop 0
    buffer_load_dwordx4 v12, s[20:23], s99 offen lds
    s_add_u32 m0, s2, 33792
    s_nop 0
    buffer_load_dwordx4 v13, s[20:23], s99 offen lds
    s_add_u32 m0, s2, 40960
    s_nop 0
    buffer_load_dwordx4 v16, s[24:27], s99 offen lds
    s_add_u32 m0, s2, 41984
    s_nop 0
    buffer_load_dwordx4 v17, s[24:27], s99 offen lds
    s_waitcnt vmcnt(8)
    s_barrier
    s_bfe_u32 s99, s101, 262152
    s_lshl_b32 s4, s99, 7
    s_add_u32 s4, s4, s68
    s_mul_i32 s99, s99, 229376
    s_add_u32 s99, s99, s69
    s_add_u32 s99, s99, 128
    s_add_u32 m0, s13, 49152
    s_nop 0
    buffer_load_dwordx4 v8, s[16:19], s4 offen lds
    s_add_u32 m0, s13, 50176
    s_nop 0
    buffer_load_dwordx4 v9, s[16:19], s4 offen lds
    s_add_u32 m0, s13, 51200
    s_nop 0
    buffer_load_dwordx4 v10, s[16:19], s4 offen lds
    s_add_u32 m0, s13, 52224
    s_nop 0
    buffer_load_dwordx4 v11, s[16:19], s4 offen lds
    s_add_u32 m0, s2, 65536
    s_nop 0
    buffer_load_dwordx4 v12, s[20:23], s99 offen lds
    s_add_u32 m0, s2, 66560
    s_nop 0
    buffer_load_dwordx4 v13, s[20:23], s99 offen lds
    s_add_u32 m0, s2, 73728
    s_nop 0
    buffer_load_dwordx4 v16, s[24:27], s99 offen lds
    s_add_u32 m0, s2, 74752
    s_nop 0
    buffer_load_dwordx4 v17, s[24:27], s99 offen lds
    v_mov_b32 v44, v26
    v_mov_b32 v45, v27
    v_mov_b32 v46, 0
    s_nop 0
    s_mov_b32 s88, 0
TAGP_1:
    v_readfirstlane_b32 s14, v44
    v_readfirstlane_b32 s15, v45
    s_cmp_eq_u32 s15, 0
    s_cbranch_scc1 TAGR_3
    s_sub_u32 vcc_lo, s14, s86
    s_add_u32 vcc_lo, vcc_lo, 800
    s_cmp_lt_u32 vcc_lo, 0x40000000
    s_cbranch_scc1 TAGD_2
    s_cmp_ge_u32 s88, 24
    s_cbranch_scc1 TAGD_2
TAGR_3:
    s_add_u32 s88, s88, 1
    s_cmp_ge_u32 s88, 20000
    s_cbranch_scc1 TAGD_2
    s_sleep 2
    buffer_load_dwordx2 v[44:45], v46, s[56:59], 0 offen sc1
    s_waitcnt vmcnt(0)
    s_branch TAGP_1
TAGD_2:
    s_mov_b32 s88, 0
CHK_4:
    s_mov_b64 s[72:73], 0
    v_cmp_ne_u64 s[74:75], s[14:15], v[66:67]
    s_or_b64 s[72:73], s[72:73], s[74:75]
    v_cmp_ne_u64 s[74:75], s[14:15], v[70:71]
    s_or_b64 s[72:73], s[72:73], s[74:75]
    v_cmp_ne_u64 s[74:75], s[14:15], v[78:79]
    s_or_b64 s[72:73], s[72:73], s[74:75]
    s_cmp_eq_u64 s[72:73], 0
    s_cbranch_scc1 CHKD_5
    s_add_u32 s88, s88, 1
    s_cmp_ge_u32 s88, 20000
    s_cbranch_scc1 CHKD_5
    s_sleep 2
    buffer_load_dwordx4 v[64:67], v55, s[36:39], s60 offen sc1
    buffer_load_dwordx4 v[68:71], v2, s[36:39], s61 offen sc1
    buffer_load_dwordx4 v[76:79], v58, s[36:39], s62 offen sc1
    s_waitcnt vmcnt(0)
    s_branch CHK_4
CHKD_5:
    v_and_b32 v67, 0xffff, v64
    v_mov_b32 v66, v64
    v_cndmask_b32 v76, v76, 0, s[80:81]
    v_cndmask_b32 v77, v77, 0, s[80:81]
    s_lshl_b32 s72, s11, 9
    v_lshl_add_u32 v44, v1, 3, s72
    s_and_b32 s73, s11, 1
    s_lshl_b32 s73, s73, 9
    v_lshl_add_u32 v45, v1, 3, s73
    s_lshl_b32 s72, s11, 7
    v_lshl_add_u32 v46, v5, 2, s72
    s_lshr_b32 s73, s11, 1
    s_lshl_b32 s73, s73, 9
    v_lshl_add_u32 v47, v5, 2, s73
    ds_write_b64 v44, v[66:67] offset:0
    ds_write_b64 v44, v[68:69] offset:2048
    ds_write_b64 v45, v[76:77] offset:6144
    ds_write_b32 v46, v65 offset:7168
    ds_write_b32 v57, v65 offset:7680
    s_waitcnt lgkmcnt(0)
    s_waitcnt lgkmcnt(0)
    s_barrier
    s_bfe_u32 s99, s101, 262156
    s_lshl_b32 s4, s99, 7
    s_add_u32 s4, s4, s68
    s_mul_i32 s99, s99, 229376
    s_add_u32 s99, s99, s69
    s_add_u32 s99, s99, 128
    s_add_u32 m0, s13, 81920
    s_nop 0
    buffer_load_dwordx4 v8, s[16:19], s4 offen lds
    s_add_u32 m0, s13, 82944
    s_nop 0
    buffer_load_dwordx4 v9, s[16:19], s4 offen lds
    s_add_u32 m0, s13, 83968
    s_nop 0
    buffer_load_dwordx4 v10, s[16:19], s4 offen lds
    s_add_u32 m0, s13, 84992
    s_nop 0
    buffer_load_dwordx4 v11, s[16:19], s4 offen lds
    s_add_u32 m0, s2, 98304
    s_nop 0
    buffer_load_dwordx4 v12, s[20:23], s99 offen lds
    s_add_u32 m0, s2, 99328
    s_nop 0
    buffer_load_dwordx4 v13, s[20:23], s99 offen lds
    s_add_u32 m0, s2, 106496
    s_nop 0
    buffer_load_dwordx4 v16, s[24:27], s99 offen lds
    s_add_u32 m0, s2, 107520
    s_nop 0
    buffer_load_dwordx4 v17, s[24:27], s99 offen lds
    s_barrier
    ds_read_b128 v[64:67], v61 offset:9216
    ds_read_b128 v[68:71], v61 offset:9232
    s_waitcnt lgkmcnt(0)
    v_fma_f32 v45, v34, v64, v65
    s_nop 0
    v_fmac_f32_dpp v45, v64, v35 quad_perm:[1,0,3,2] row_mask:0xf bank_mask:0xf
    s_nop 0
    v_fma_f32 v44, v34, v45, v66
    s_nop 0
    v_fmac_f32_dpp v44, v45, v35 quad_perm:[1,0,3,2] row_mask:0xf bank_mask:0xf
    s_nop 0
    v_fma_f32 v45, v34, v44, v67
    s_nop 0
    v_fmac_f32_dpp v45, v44, v35 quad_perm:[1,0,3,2] row_mask:0xf bank_mask:0xf
    s_nop 0
    v_fma_f32 v44, v34, v45, v68
    s_nop 0
    v_fmac_f32_dpp v44, v45, v35 quad_perm:[1,0,3,2] row_mask:0xf bank_mask:0xf
    s_nop 0
    v_fma_f32 v45, v34, v44, v69
    s_nop 0
    v_fmac_f32_dpp v45, v44, v35 quad_perm:[1,0,3,2] row_mask:0xf bank_mask:0xf
    s_nop 0
    v_fma_f32 v44, v34, v45, v70
    s_nop 0
    v_fmac_f32_dpp v44, v45, v35 quad_perm:[1,0,3,2] row_mask:0xf bank_mask:0xf
    s_nop 0
    v_fma_f32 v45, v34, v44, v71
    s_nop 0
    v_fmac_f32_dpp v45, v44, v35 quad_perm:[1,0,3,2] row_mask:0xf bank_mask:0xf
    s_nop 0
    v_mov_b32 v72, v45
    v_mov_b32 v73, 0
    v_mov_b32 v74, s14
    v_mov_b32 v75, s15
    buffer_store_dwordx4 v[72:75], v58, s[36:39], s90 offen sc1
    s_waitcnt vmcnt(17)
    s_barrier
    s_bfe_u32 s99, s101, 262160
    s_lshl_b32 s4, s99, 7
    s_add_u32 s4, s4, s68
    s_mul_i32 s99, s99, 229376
    s_add_u32 s99, s99, s69
    s_add_u32 s99, s99, 128
    s_add_u32 m0, s13, 114688
    s_nop 0
    buffer_load_dwordx4 v8, s[16:19], s4 offen lds
    s_add_u32 m0, s13, 115712
    s_nop 0
    buffer_load_dwordx4 v9, s[16:19], s4 offen lds
    s_add_u32 m0, s13, 116736
    s_nop 0
    buffer_load_dwordx4 v10, s[16:19], s4 offen lds
    s_add_u32 m0, s13, 117760
    s_nop 0
    buffer_load_dwordx4 v11, s[16:19], s4 offen lds
    s_add_u32 m0, s2, 131072
    s_nop 0
    buffer_load_dwordx4 v12, s[20:23], s99 offen lds
    s_add_u32 m0, s2, 132096
    s_nop 0
    buffer_load_dwordx4 v13, s[20:23], s99 offen lds
    s_add_u32 m0, s2, 139264
    s_nop 0
    buffer_load_dwordx4 v16, s[24:27], s99 offen lds
    s_add_u32 m0, s2, 140288
    s_nop 0
    buffer_load_dwordx4 v17, s[24:27], s99 offen lds
    s_waitcnt vmcnt(17)
    s_barrier
    s_bfe_u32 s99, s101, 262164
    s_lshl_b32 s4, s99, 7
    s_add_u32 s4, s4, s68
    s_mul_i32 s99, s99, 229376
    s_add_u32 s99, s99, s69
    s_add_u32 s99, s99, 128
    s_add_u32 m0, s13, 16384
    s_nop 0
    buffer_load_dwordx4 v8, s[16:19], s4 offen lds
    s_add_u32 m0, s13, 17408
    s_nop 0
    buffer_load_dwordx4 v9, s[16:19], s4 offen lds
    s_add_u32 m0, s13, 18432
    s_nop 0
    buffer_load_dwordx4 v10, s[16:19], s4 offen lds
    s_add_u32 m0, s13, 19456
    s_nop 0
    buffer_load_dwordx4 v11, s[16:19], s4 offen lds
    s_add_u32 m0, s2, 32768
    s_nop 0
    buffer_load_dwordx4 v12, s[20:23], s99 offen lds
    s_add_u32 m0, s2, 33792
    s_nop 0
    buffer_load_dwordx4 v13, s[20:23], s99 offen lds
    s_add_u32 m0, s2, 40960
    s_nop 0
    buffer_load_dwordx4 v16, s[24:27], s99 offen lds
    s_add_u32 m0, s2, 41984
    s_nop 0
    buffer_load_dwordx4 v17, s[24:27], s99 offen lds
    buffer_load_dwordx4 v[76:79], v2, s[36:39], s63 offen sc1
    s_waitcnt vmcnt(18)
    s_barrier
    s_bfe_u32 s99, s101, 262168
    s_lshl_b32 s4, s99, 7
    s_add_u32 s4, s4, s68
    s_mul_i32 s99, s99, 229376
    s_add_u32 s99, s99, s69
    s_add_u32 s99, s99, 128
    s_add_u32 m0, s13, 49152
    s_nop 0
    buffer_load_dwordx4 v8, s[16:19], s4 offen lds
    s_add_u32 m0, s13, 50176
    s_nop 0
    buffer_load_dwordx4 v9, s[16:19], s4 offen lds
    s_add_u32 m0, s13, 51200
    s_nop 0
    buffer_load_dwordx4 v10, s[16:19], s4 offen lds
    s_add_u32 m0, s13, 52224
    s_nop 0
    buffer_load_dwordx4 v11, s[16:19], s4 offen lds
    s_add_u32 m0, s2, 65536
    s_nop 0
    buffer_load_dwordx4 v12, s[20:23], s99 offen lds
    s_add_u32 m0, s2, 66560
    s_nop 0
    buffer_load_dwordx4 v13, s[20:23], s99 offen lds
    s_add_u32 m0, s2, 73728
    s_nop 0
    buffer_load_dwordx4 v16, s[24:27], s99 offen lds
    s_add_u32 m0, s2, 74752
    s_nop 0
    buffer_load_dwordx4 v17, s[24:27], s99 offen lds
    s_cmp_lg_u32 s10, 7
    s_cbranch_scc1 NOFLAG_6
    v_mov_b32 v44, s14
    v_mov_b32 v45, s15
    v_lshlrev_b32 v46, 7, v1
    s_add_u32 s77, s89, 0
    s_mov_b64 exec, 0x3fff
    buffer_store_dwordx2 v[44:45], v46, s[36:39], s77 offen sc1
    s_mov_b64 exec, -1
NOFLAG_6:
    buffer_load_dwordx4 v[80:83], v60, s[36:39], s91 offen offset:3584 sc1
    buffer_load_dwordx4 v[84:87], v60, s[36:39], s91 offen offset:3072 sc1
    buffer_load_dwordx4 v[88:91], v60, s[36:39], s91 offen offset:2560 sc1
    buffer_load_dwordx4 v[92:95], v60, s[36:39], s91 offen offset:2048 sc1
    s_waitcnt vmcnt(21)
    s_barrier
    s_bfe_u32 s5, s100, 262144
    s_mul_i32 s5, s5, 229376
    s_add_u32 s5, s5, s83
    s_add_u32 m0, s13, 81920
    s_nop 0
    buffer_load_dwordx4 v22, s[40:43], s5 offen lds
    s_add_u32 m0, s13, 82944
    s_nop 0
    buffer_load_dwordx4 v23, s[40:43], s5 offen lds
    s_add_u32 s5, s5, 14336
    s_add_u32 m0, s13, 83968
    s_nop 0
    buffer_load_dwordx4 v22, s[40:43], s5 offen lds
    s_add_u32 m0, s13, 84992
    s_nop 0
    buffer_load_dwordx4 v23, s[40:43], s5 offen lds
    s_bfe_u32 s5, s100, 262148
    s_mul_i32 s5, s5, 229376
    s_add_u32 s5, s5, s83
    s_add_u32 m0, s13, 98304
    s_nop 0
    buffer_load_dwordx4 v22, s[40:43], s5 offen lds
    s_add_u32 m0, s13, 99328
    s_nop 0
    buffer_load_dwordx4 v23, s[40:43], s5 offen lds
    s_add_u32 s5, s5, 14336
    s_add_u32 m0, s13, 100352
    s_nop 0
    buffer_load_dwordx4 v22, s[40:43], s5 offen lds
    s_add_u32 m0, s13, 101376
    s_nop 0
    buffer_load_dwordx4 v23, s[40:43], s5 offen lds
    buffer_load_dwordx4 v[96:99], v60, s[36:39], s91 offen offset:1536 sc1
    buffer_load_dwordx4 v[100:103], v60, s[36:39], s91 offen offset:1024 sc1
    buffer_load_dwordx4 v[104:107], v60, s[36:39], s91 offen offset:512 sc1
    buffer_load_dwordx4 v[108:111], v60, s[36:39], s91 offen offset:0 sc1
    s_waitcnt vmcnt(24)
    s_mov_b32 s88, 0
CHK_7:
    v_cmp_ne_u64 s[72:73], s[14:15], v[78:79]
    s_cmp_eq_u64 s[72:73], 0
    s_cbranch_scc1 CHKD_8
    s_add_u32 s88, s88, 1
    s_cmp_ge_u32 s88, 20000
    s_cbranch_scc1 CHKD_8
    s_sleep 2
    buffer_load_dwordx4 v[76:79], v2, s[36:39], s63 offen sc1
    s_waitcnt vmcnt(0)
    s_branch CHK_7
CHKD_8:
    s_lshl_b32 s72, s11, 9
    v_lshl_add_u32 v63, v1, 3, s72
    ds_write_b64 v63, v[76:77] offset:4096
    s_waitcnt lgkmcnt(0)
    s_barrier
    s_bfe_u32 s5, s100, 262152
    s_mul_i32 s5, s5, 229376
    s_add_u32 s5, s5, s83
    s_add_u32 m0, s13, 114688
    s_nop 0
    buffer_load_dwordx4 v22, s[40:43], s5 offen lds
    s_add_u32 m0, s13, 115712
    s_nop 0
    buffer_load_dwordx4 v23, s[40:43], s5 offen lds
    s_add_u32 s5, s5, 14336
    s_add_u32 m0, s13, 116736
    s_nop 0
    buffer_load_dwordx4 v22, s[40:43], s5 offen lds
    s_add_u32 m0, s13, 117760
    s_nop 0
    buffer_load_dwordx4 v23, s[40:43], s5 offen lds
    s_bfe_u32 s5, s100, 262156
    s_mul_i32 s5, s5, 229376
    s_add_u32 s5, s5, s83
    s_add_u32 m0, s13, 131072
    s_nop 0
    buffer_load_dwordx4 v22, s[40:43], s5 offen lds
    s_add_u32 m0, s13, 132096
    s_nop 0
    buffer_load_dwordx4 v23, s[40:43], s5 offen lds
    s_add_u32 s5, s5, 14336
    s_add_u32 m0, s13, 133120
    s_nop 0
    buffer_load_dwordx4 v22, s[40:43], s5 offen lds
    s_add_u32 m0, s13, 134144
    s_nop 0
    buffer_load_dwordx4 v23, s[40:43], s5 offen lds
    s_add_u32 s77, s3, 0
    buffer_load_dwordx2 v[26:27], v7, s[36:39], s77 offen sc1
    s_waitcnt vmcnt(9)
    s_barrier
    s_bfe_u32 s5, s100, 262160
    s_mul_i32 s5, s5, 229376
    s_add_u32 s5, s5, s83
    s_add_u32 m0, s13, 16384
    s_nop 0
    buffer_load_dwordx4 v22, s[40:43], s5 offen lds
    s_mov_b64 s[72:73], 0
    v_cmp_ne_u64 s[74:75], s[14:15], v[82:83]
    v_cmp_le_i32 vcc, 0, v59
    s_and_b64 s[74:75], s[74:75], vcc
    s_or_b64 s[72:73], s[72:73], s[74:75]
    v_cndmask_b32 v81, 0, v80, vcc
    v_cmp_ne_u64 s[74:75], s[14:15], v[86:87]
    v_cmp_le_i32 vcc, 1, v59
    s_and_b64 s[74:75], s[74:75], vcc
    s_or_b64 s[72:73], s[72:73], s[74:75]
    v_cndmask_b32 v85, 0, v84, vcc
    v_cmp_ne_u64 s[74:75], s[14:15], v[90:91]
    v_cmp_le_i32 vcc, 2, v59
    s_add_u32 m0, s13, 17408
    s_nop 0
    buffer_load_dwordx4 v23, s[40:43], s5 offen lds
    s_and_b64 s[74:75], s[74:75], vcc
    s_or_b64 s[72:73], s[72:73], s[74:75]
    v_cndmask_b32 v89, 0, v88, vcc
    v_cmp_ne_u64 s[74:75], s[14:15], v[94:95]
    v_cmp_le_i32 vcc, 3, v59
    s_and_b64 s[74:75], s[74:75], vcc
    s_or_b64 s[72:73], s[72:73], s[74:75]
    v_cndmask_b32 v93, 0, v92, vcc
    v_cmp_ne_u64 s[74:75], s[14:15], v[98:99]
    v_cmp_le_i32 vcc, 4, v59
    s_and_b64 s[74:75], s[74:75], vcc
    s_or_b64 s[72:73], s[72:73], s[74:75]
    v_cndmask_b32 v97, 0, v96, vcc
    v_cmp_ne_u64 s[74:75], s[14:15], v[102:103]
    s_add_u32 s5, s5, 14336
    s_add_u32 m0, s13, 18432
    s_nop 0
    buffer_load_dwordx4 v22, s[40:43], s5 offen lds
    v_cmp_le_i32 vcc, 5, v59
    s_and_b64 s[74:75], s[74:75], vcc
    s_or_b64 s[72:73], s[72:73], s[74:75]
    v_cndmask_b32 v101, 0, v100, vcc
    v_cmp_ne_u64 s[74:75], s[14:15], v[106:107]
    v_cmp_le_i32 vcc, 6, v59
    s_and_b64 s[74:75], s[74:75], vcc
    s_or_b64 s[72:73], s[72:73], s[74:75]
    v_cndmask_b32 v105, 0, v104, vcc
    v_cmp_ne_u64 s[74:75], s[14:15], v[110:111]
    v_cmp_le_i32 vcc, 7, v59
    s_and_b64 s[74:75], s[74:75], vcc
    s_or_b64 s[72:73], s[72:73], s[74:75]
    v_cndmask_b32 v109, 0, v108, vcc
    s_add_u32 m0, s13, 19456
    s_nop 0
    buffer_load_dwordx4 v23, s[40:43], s5 offen lds
    s_bfe_u32 s5, s100, 262164
    s_mul_i32 s5, s5, 229376
    s_add_u32 s5, s5, s83
    s_add_u32 m0, s13, 32768
    s_nop 0
    buffer_load_dwordx4 v22, s[40:43], s5 offen lds
    s_add_u32 m0, s13, 33792
    s_nop 0
    buffer_load_dwordx4 v23, s[40:43], s5 offen lds
    s_add_u32 s5, s5, 14336
    s_add_u32 m0, s13, 34816
    s_nop 0
    buffer_load_dwordx4 v22, s[40:43], s5 offen lds
    s_add_u32 m0, s13, 35840
    s_nop 0
    buffer_load_dwordx4 v23, s[40:43], s5 offen lds
    s_cmp_eq_u64 s[72:73], 0
    s_cbranch_scc1 EOK_9
    buffer_load_dwordx4 v[80:83], v60, s[36:39], s91 offen offset:3584 sc1
    buffer_load_dwordx4 v[84:87], v60, s[36:39], s91 offen offset:3072 sc1
    buffer_load_dwordx4 v[88:91], v60, s[36:39], s91 offen offset:2560 sc1
    buffer_load_dwordx4 v[92:95], v60, s[36:39], s91 offen offset:2048 sc1
    buffer_load_dwordx4 v[96:99], v60, s[36:39], s91 offen offset:1536 sc1
    buffer_load_dwordx4 v[100:103], v60, s[36:39], s91 offen offset:1024 sc1
    buffer_load_dwordx4 v[104:107], v60, s[36:39], s91 offen offset:512 sc1
    buffer_load_dwordx4 v[108:111], v60, s[36:39], s91 offen offset:0 sc1
    s_waitcnt vmcnt(0)
    s_mov_b32 s88, 0
CHK_10:
    s_mov_b64 s[72:73], 0
    v_cmp_ne_u64 s[74:75], s[14:15], v[82:83]
    v_cmp_le_i32 vcc, 0, v59
    s_and_b64 s[74:75], s[74:75], vcc
    s_or_b64 s[72:73], s[72:73], s[74:75]
    v_cndmask_b32 v81, 0, v80, vcc
    v_cmp_ne_u64 s[74:75], s[14:15], v[86:87]
    v_cmp_le_i32 vcc, 1, v59
    s_and_b64 s[74:75], s[74:75], vcc
    s_or_b64 s[72:73], s[72:73], s[74:75]
    v_cndmask_b32 v85, 0, v84, vcc
    v_cmp_ne_u64 s[74:75], s[14:15], v[90:91]
    v_cmp_le_i32 vcc, 2, v59
    s_and_b64 s[74:75], s[74:75], vcc
    s_or_b64 s[72:73], s[72:73], s[74:75]
    v_cndmask_b32 v89, 0, v88, vcc
    v_cmp_ne_u64 s[74:75], s[14:15], v[94:95]
    v_cmp_le_i32 vcc, 3, v59
    s_and_b64 s[74:75], s[74:75], vcc
    s_or_b64 s[72:73], s[72:73], s[74:75]
    v_cndmask_b32 v93, 0, v92, vcc
    v_cmp_ne_u64 s[74:75], s[14:15], v[98:99]
    v_cmp_le_i32 vcc, 4, v59
    s_and_b64 s[74:75], s[74:75], vcc
    s_or_b64 s[72:73], s[72:73], s[74:75]
    v_cndmask_b32 v97, 0, v96, vcc
    v_cmp_ne_u64 s[74:75], s[14:15], v[102:103]
    v_cmp_le_i32 vcc, 5, v59
    s_and_b64 s[74:75], s[74:75], vcc
    s_or_b64 s[72:73], s[72:73], s[74:75]
    v_cndmask_b32 v101, 0, v100, vcc
    v_cmp_ne_u64 s[74:75], s[14:15], v[106:107]
    v_cmp_le_i32 vcc, 6, v59
    s_and_b64 s[74:75], s[74:75], vcc
    s_or_b64 s[72:73], s[72:73], s[74:75]
    v_cndmask_b32 v105, 0, v104, vcc
    v_cmp_ne_u64 s[74:75], s[14:15], v[110:111]
    v_cmp_le_i32 vcc, 7, v59
    s_and_b64 s[74:75], s[74:75], vcc
    s_or_b64 s[72:73], s[72:73], s[74:75]
    v_cndmask_b32 v109, 0, v108, vcc
    s_cmp_eq_u64 s[72:73], 0
    s_cbranch_scc1 CHKD_11
    s_add_u32 s88, s88, 1
    s_cmp_ge_u32 s88, 20000
    s_cbranch_scc1 CHKD_11
    s_sleep 4
    buffer_load_dwordx4 v[80:83], v60, s[36:39], s91 offen offset:3584 sc1
    buffer_load_dwordx4 v[84:87], v60, s[36:39], s91 offen offset:3072 sc1
    buffer_load_dwordx4 v[88:91], v60, s[36:39], s91 offen offset:2560 sc1
    buffer_load_dwordx4 v[92:95], v60, s[36:39], s91 offen offset:2048 sc1
    buffer_load_dwordx4 v[96:99], v60, s[36:39], s91 offen offset:1536 sc1
    buffer_load_dwordx4 v[100:103], v60, s[36:39], s91 offen offset:1024 sc1
    buffer_load_dwordx4 v[104:107], v60, s[36:39], s91 offen offset:512 sc1
    buffer_load_dwordx4 v[108:111], v60, s[36:39], s91 offen offset:0 sc1
    s_waitcnt vmcnt(0)
    s_branch CHK_10
CHKD_11:
EOK_9:
    s_waitcnt vmcnt(8)
    s_mov_b32 s88, 0
CHK_12:
    v_cmp_ne_u64 s[72:73], s[14:15], v[26:27]
    s_cmp_eq_u64 s[72:73], 0
    s_cbranch_scc1 CHKD_13
    s_add_u32 s88, s88, 1
    s_cmp_ge_u32 s88, 20000
    s_cbranch_scc1 CHKD_13
    s_sleep 3
    s_add_u32 s77, s3, 0
    buffer_load_dwordx2 v[26:27], v7, s[36:39], s77 offen sc1
    s_waitcnt vmcnt(0)
    s_branch CHK_12
CHKD_13:
    s_barrier
    s_bfe_u32 s4, s100, 262144
    s_lshl_b32 s4, s4, 14
    s_add_u32 s4, s4, s82
    s_add_u32 m0, s13, 49152
    s_nop 0
    buffer_load_dwordx4 v2, s[36:39], s4 offen offset:0 lds
    buffer_load_dwordx4 v2, s[36:39], s4 offen offset:1024 lds
    buffer_load_dwordx4 v2, s[36:39], s4 offen offset:2048 lds
    buffer_load_dwordx4 v2, s[36:39], s4 offen offset:3072 lds
    s_bfe_u32 s4, s100, 262148
    s_lshl_b32 s4, s4, 14
    s_add_u32 s4, s4, s82
    s_add_u32 m0, s13, 65536
    s_nop 0
    buffer_load_dwordx4 v2, s[36:39], s4 offen offset:0 lds
    buffer_load_dwordx4 v2, s[36:39], s4 offen offset:1024 lds
    buffer_load_dwordx4 v2, s[36:39], s4 offen offset:2048 lds
    buffer_load_dwordx4 v2, s[36:39], s4 offen offset:3072 lds
    v_fma_f32 v44, v36, v109, v105
    s_nop 0
    v_fmac_f32_dpp v44, v109, v37 quad_perm:[1,0,3,2] row_mask:0xf bank_mask:0xf
    s_nop 0
    v_fma_f32 v45, v36, v44, v101
    s_nop 0
    v_fmac_f32_dpp v45, v44, v37 quad_perm:[1,0,3,2] row_mask:0xf bank_mask:0xf
    s_nop 0
    v_fma_f32 v44, v36, v45, v97
    s_nop 0
    v_fmac_f32_dpp v44, v45, v37 quad_perm:[1,0,3,2] row_mask:0xf bank_mask:0xf
    s_nop 0
    v_fma_f32 v45, v36, v44, v93
    s_nop 0
    v_fmac_f32_dpp v45, v44, v37 quad_perm:[1,0,3,2] row_mask:0xf bank_mask:0xf
    s_nop 0
    v_fma_f32 v44, v36, v45, v89
    s_nop 0
    v_fmac_f32_dpp v44, v45, v37 quad_perm:[1,0,3,2] row_mask:0xf bank_mask:0xf
    s_nop 0
    v_fma_f32 v45, v36, v44, v85
    s_nop 0
    v_fmac_f32_dpp v45, v44, v37 quad_perm:[1,0,3,2] row_mask:0xf bank_mask:0xf
    s_nop 0
    v_fma_f32 v44, v36, v45, v81
    s_nop 0
    v_fmac_f32_dpp v44, v45, v37 quad_perm:[1,0,3,2] row_mask:0xf bank_mask:0xf
    s_nop 0
    v_mov_b32 v46, v44
    v_mov_b32 v47, v44
    s_nop 1
    v_permlane32_swap_b32 v46, v47
    s_nop 1
    v_fma_f32 v44, v38, v47, v46
    s_nop 0
    v_fmac_f32_dpp v44, v47, v39 quad_perm:[1,0,3,2] row_mask:0xf bank_mask:0xf
    s_nop 0
    ds_write_b32 v62, v44 offset:11264
    v_fma_f32 v45, v34, v44, v64
    s_nop 0
    v_fmac_f32_dpp v45, v44, v35 quad_perm:[1,0,3,2] row_mask:0xf bank_mask:0xf
    s_nop 0
    ds_write_b32 v62, v45 offset:11392
    v_fma_f32 v44, v34, v45, v65
    s_nop 0
    v_fmac_f32_dpp v44, v45, v35 quad_perm:[1,0,3,2] row_mask:0xf bank_mask:0xf
    s_nop 0
    ds_write_b32 v62, v44 offset:11520
    v_fma_f32 v45, v34, v44, v66
    s_nop 0
    v_fmac_f32_dpp v45, v44, v35 quad_perm:[1,0,3,2] row_mask:0xf bank_mask:0xf
    s_nop 0
    ds_write_b32 v62, v45 offset:11648
    v_fma_f32 v44, v34, v45, v67
    s_nop 0
    v_fmac_f32_dpp v44, v45, v35 quad_perm:[1,0,3,2] row_mask:0xf bank_mask:0xf
    s_nop 0
    ds_write_b32 v62, v44 offset:11776
    v_fma_f32 v45, v34, v44, v68
    s_nop 0
    v_fmac_f32_dpp v45, v44, v35 quad_perm:[1,0,3,2] row_mask:0xf bank_mask:0xf
    s_nop 0
    ds_write_b32 v62, v45 offset:11904
    v_fma_f32 v44, v34, v45, v69
    s_nop 0
    v_fmac_f32_dpp v44, v45, v35 quad_perm:[1,0,3,2] row_mask:0xf bank_mask:0xf
    s_nop 0
    ds_write_b32 v62, v44 offset:12032
    v_fma_f32 v45, v34, v44, v70
    s_nop 0
    v_fmac_f32_dpp v45, v44, v35 quad_perm:[1,0,3,2] row_mask:0xf bank_mask:0xf
    s_nop 0
    ds_write_b32 v62, v45 offset:12160
    s_waitcnt lgkmcnt(0)
    s_waitcnt vmcnt(4)
    s_barrier
    s_waitcnt vmcnt(0)
    s_barrier
    s_bfe_u32 s4, s100, 262152
    s_lshl_b32 s4, s4, 14
    s_add_u32 s4, s4, s82
    s_add_u32 m0, s13, 49152
    s_nop 0
    buffer_load_dwordx4 v2, s[36:39], s4 offen offset:0 lds
    buffer_load_dwordx4 v2, s[36:39], s4 offen offset:1024 lds
    buffer_load_dwordx4 v2, s[36:39], s4 offen offset:2048 lds
    buffer_load_dwordx4 v2, s[36:39], s4 offen offset:3072 lds
    s_bfe_u32 s4, s100, 262156
    s_lshl_b32 s4, s4, 14
    s_add_u32 s4, s4, s82
    s_add_u32 m0, s13, 81920
    s_nop 0
    buffer_load_dwordx4 v2, s[36:39], s4 offen offset:0 lds
    buffer_load_dwordx4 v2, s[36:39], s4 offen offset:1024 lds
    buffer_load_dwordx4 v2, s[36:39], s4 offen offset:2048 lds
    buffer_load_dwordx4 v2, s[36:39], s4 offen offset:3072 lds
    s_waitcnt vmcnt(4)
    s_barrier
    s_cmp_lg_u32 s10, 7
    s_cbranch_scc1 NOFLAG_14
    v_mov_b32 v44, s14
    v_mov_b32 v45, s15
    v_lshlrev_b32 v46, 7, v1
    s_add_u32 s77, s89, 32768
    s_mov_b64 exec, 0x3fff
    buffer_store_dwordx2 v[44:45], v46, s[36:39], s77 offen sc1
    s_mov_b64 exec, -1
NOFLAG_14:
    s_bfe_u32 s4, s100, 262160
    s_lshl_b32 s4, s4, 14
    s_add_u32 s4, s4, s82
    s_add_u32 m0, s13, 65536
    s_nop 0
    buffer_load_dwordx4 v2, s[36:39], s4 offen offset:0 lds
    buffer_load_dwordx4 v2, s[36:39], s4 offen offset:1024 lds
    buffer_load_dwordx4 v2, s[36:39], s4 offen offset:2048 lds
    buffer_load_dwordx4 v2, s[36:39], s4 offen offset:3072 lds
    s_bfe_u32 s4, s100, 262164
    s_lshl_b32 s4, s4, 14
    s_add_u32 s4, s4, s82
    s_add_u32 m0, s13, 98304
    s_nop 0
    buffer_load_dwordx4 v2, s[36:39], s4 offen offset:0 lds
    buffer_load_dwordx4 v2, s[36:39], s4 offen offset:1024 lds
    buffer_load_dwordx4 v2, s[36:39], s4 offen offset:2048 lds
    buffer_load_dwordx4 v2, s[36:39], s4 offen offset:3072 lds
    v_mul_u32_u24 v44, 896, v3
    v_lshl_add_u32 v44, v4, 4, v44
    v_add_u32 v45, 7168, v44
    s_lshl_b32 s72, s8, 6
    s_lshl_b32 s73, s11, 4
    s_add_u32 s72, s72, s73
    s_mul_i32 s72, s72, 896
    s_lshl_b32 s73, s9, 7
    s_add_u32 s72, s72, s73
    s_lshl_b32 s74, s8, 10
    s_add_u32 s74, s74, 11534336
    s_add_u32 m0, s2, 0
    s_nop 0
    buffer_load_dwordx4 v44, s[16:19], s72 offen lds
    s_add_u32 m0, s2, 1024
    s_nop 0
    buffer_load_dwordx4 v45, s[16:19], s72 offen lds
    s_mov_b32 m0, 8192
    s_nop 0
    buffer_load_dwordx4 v2, s[36:39], s74 offen sc1 lds
    s_waitcnt vmcnt(11)
    s_barrier
    s_bfe_u32 s4, s100, 262168
    s_lshl_b32 s4, s4, 14
    s_add_u32 s4, s4, s82
    s_add_u32 m0, s13, 49152
    s_nop 0
    buffer_load_dwordx4 v2, s[36:39], s4 offen offset:0 lds
    buffer_load_dwordx4 v2, s[36:39], s4 offen offset:1024 lds
    buffer_load_dwordx4 v2, s[36:39], s4 offen offset:2048 lds
    buffer_load_dwordx4 v2, s[36:39], s4 offen offset:3072 lds
    s_bfe_u32 s5, s100, 262168
    s_mul_i32 s5, s5, 229376
    s_add_u32 s5, s5, s83
    s_add_u32 m0, s13, 114688
    s_nop 0
    buffer_load_dwordx4 v22, s[40:43], s5 offen lds
    s_add_u32 m0, s13, 115712
    s_nop 0
    buffer_load_dwordx4 v23, s[40:43], s5 offen lds
    s_add_u32 s5, s5, 14336
    s_add_u32 m0, s13, 116736
    s_nop 0
    buffer_load_dwordx4 v22, s[40:43], s5 offen lds
    s_add_u32 m0, s13, 117760
    s_nop 0
    buffer_load_dwordx4 v23, s[40:43], s5 offen lds
    s_add_u32 s77, s3, 32768
    buffer_load_dwordx2 v[26:27], v7, s[36:39], s77 offen sc1
    s_waitcnt vmcnt(16)
    s_barrier
    s_bfe_u32 s5, s100, 262144
    s_mul_i32 s5, s5, 229376
    s_add_u32 s5, s5, s83
    s_add_u32 s5, s5, 57344
    s_add_u32 m0, s13, 81920
    s_nop 0
    buffer_load_dwordx4 v22, s[40:43], s5 offen lds
    s_add_u32 m0, s13, 82944
    s_nop 0
    buffer_load_dwordx4 v23, s[40:43], s5 offen lds
    s_add_u32 s5, s5, 14336
    s_add_u32 m0, s13, 83968
    s_nop 0
    buffer_load_dwordx4 v22, s[40:43], s5 offen lds
    s_add_u32 m0, s13, 84992
    s_nop 0
    buffer_load_dwordx4 v23, s[40:43], s5 offen lds
    s_bfe_u32 s5, s100, 262148
    s_mul_i32 s5, s5, 229376
    s_add_u32 s5, s5, s83
    s_add_u32 s5, s5, 57344
    s_add_u32 m0, s13, 131072
    s_nop 0
    buffer_load_dwordx4 v22, s[40:43], s5 offen lds
    s_add_u32 m0, s13, 132096
    s_nop 0
    buffer_load_dwordx4 v23, s[40:43], s5 offen lds
    s_add_u32 s5, s5, 14336
    s_add_u32 m0, s13, 133120
    s_nop 0
    buffer_load_dwordx4 v22, s[40:43], s5 offen lds
    s_add_u32 m0, s13, 134144
    s_nop 0
    buffer_load_dwordx4 v23, s[40:43], s5 offen lds
    s_waitcnt vmcnt(20)
    s_barrier
    s_waitcnt vmcnt(8)
    s_mov_b32 s88, 0
CHK_15:
    v_cmp_ne_u64 s[72:73], s[14:15], v[26:27]
    s_cmp_eq_u64 s[72:73], 0
    s_cbranch_scc1 CHKD_16
    s_add_u32 s88, s88, 1
    s_cmp_ge_u32 s88, 20000
    s_cbranch_scc1 CHKD_16
    s_sleep 3
    s_add_u32 s77, s3, 32768
    buffer_load_dwordx2 v[26:27], v7, s[36:39], s77 offen sc1
    s_waitcnt vmcnt(0)
    s_branch CHK_15
CHKD_16:
    s_bfe_u32 s4, s100, 262144
    s_lshl_b32 s4, s4, 14
    s_add_u32 s4, s4, s82
    s_add_u32 s4, s4, 4096
    s_add_u32 m0, s13, 65536
    s_nop 0
    buffer_load_dwordx4 v2, s[36:39], s4 offen offset:0 lds
    buffer_load_dwordx4 v2, s[36:39], s4 offen offset:1024 lds
    buffer_load_dwordx4 v2, s[36:39], s4 offen offset:2048 lds
    buffer_load_dwordx4 v2, s[36:39], s4 offen offset:3072 lds
    s_bfe_u32 s4, s100, 262148
    s_lshl_b32 s4, s4, 14
    s_add_u32 s4, s4, s82
    s_add_u32 s4, s4, 4096
    s_add_u32 m0, s13, 16384
    s_nop 0
    buffer_load_dwordx4 v2, s[36:39], s4 offen offset:0 lds
    buffer_load_dwordx4 v2, s[36:39], s4 offen offset:1024 lds
    buffer_load_dwordx4 v2, s[36:39], s4 offen offset:2048 lds
    buffer_load_dwordx4 v2, s[36:39], s4 offen offset:3072 lds
    s_barrier
    s_add_u32 s72, s13, 147456
    v_bfe_u32 v44, v1, 2, 2
    v_lshl_add_u32 v44, v44, 1, v6
    v_and_b32 v45, 1, v1
    v_bfe_u32 v46, v1, 4, 1
    v_lshl_add_u32 v45, v45, 1, v46
    v_xor_b32 v45, v45, v44
    v_lshlrev_b32 v44, 7, v44
    v_lshl_add_u32 v44, v45, 4, v44
    v_bfe_u32 v45, v1, 1, 1
    v_lshl_add_u32 v44, v45, 3, v44
    v_add_u32 v44, s72, v44
    v_xor_b32 v45, 64, v44
    s_lshl_b32 s72, s6, 2
    s_and_b32 s73, s11, 1
    s_lshl_b32 s73, s73, 1
    s_add_u32 s72, s72, s73
    s_mul_i32 s72, s72, 168
    s_lshl_b32 s73, s7, 2
    s_add_u32 s72, s72, s73
    s_and_b32 s73, s11, 2
    s_add_u32 s72, s72, s73
    s_add_u32 s72, s72, 112
    s_lshl_b32 s72, s72, 10
    ds_read_b64_tr_b16 v[80:81], v44 offset:0
    ds_read_b64_tr_b16 v[82:83], v44 offset:1024
    ds_read_b64_tr_b16 v[84:85], v44 offset:2048
    ds_read_b64_tr_b16 v[86:87], v44 offset:3072
    ds_read_b64_tr_b16 v[88:89], v45 offset:0
    ds_read_b64_tr_b16 v[90:91], v45 offset:1024
    ds_read_b64_tr_b16 v[92:93], v45 offset:2048
    ds_read_b64_tr_b16 v[94:95], v45 offset:3072
    s_mov_b32 s71, s72
    s_bfe_u32 s4, s100, 262152
    s_lshl_b32 s4, s4, 14
    s_add_u32 s4, s4, s82
    s_add_u32 s4, s4, 4096
    s_add_u32 m0, s13, 98304
    s_nop 0
    buffer_load_dwordx4 v2, s[36:39], s4 offen offset:0 lds
    buffer_load_dwordx4 v2, s[36:39], s4 offen offset:1024 lds
    buffer_load_dwordx4 v2, s[36:39], s4 offen offset:2048 lds
    buffer_load_dwordx4 v2, s[36:39], s4 offen offset:3072 lds
    s_bfe_u32 s5, s100, 262152
    s_mul_i32 s5, s5, 229376
    s_add_u32 s5, s5, s83
    s_add_u32 s5, s5, 57344
    s_add_u32 m0, s13, 32768
    s_nop 0
    buffer_load_dwordx4 v22, s[40:43], s5 offen lds
    s_add_u32 m0, s13, 33792
    s_nop 0
    buffer_load_dwordx4 v23, s[40:43], s5 offen lds
    s_add_u32 s5, s5, 14336
    s_add_u32 m0, s13, 34816
    s_nop 0
    buffer_load_dwordx4 v22, s[40:43], s5 offen lds
    s_add_u32 m0, s13, 35840
    s_nop 0
    buffer_load_dwordx4 v23, s[40:43], s5 offen lds
    s_waitcnt lgkmcnt(0)
    s_add_u32 s77, s71, 0
    buffer_store_dwordx4 v[80:83], v2, s[36:39], s77 offen sc1
    s_add_u32 s77, s71, 1024
    buffer_store_dwordx4 v[84:87], v2, s[36:39], s77 offen sc1
    s_add_u32 s77, s71, 172032
    buffer_store_dwordx4 v[88:91], v2, s[36:39], s77 offen sc1
    s_add_u32 s77, s71, 173056
    buffer_store_dwordx4 v[92:95], v2, s[36:39], s77 offen sc1
    s_waitcnt vmcnt(16)
    s_barrier
    s_bfe_u32 s4, s100, 262156
    s_lshl_b32 s4, s4, 14
    s_add_u32 s4, s4, s82
    s_add_u32 s4, s4, 4096
    s_add_u32 m0, s13, 49152
    s_nop 0
    buffer_load_dwordx4 v2, s[36:39], s4 offen offset:0 lds
    buffer_load_dwordx4 v2, s[36:39], s4 offen offset:1024 lds
    buffer_load_dwordx4 v2, s[36:39], s4 offen offset:2048 lds
    buffer_load_dwordx4 v2, s[36:39], s4 offen offset:3072 lds
    s_bfe_u32 s5, s100, 262156
    s_mul_i32 s5, s5, 229376
    s_add_u32 s5, s5, s83
    s_add_u32 s5, s5, 57344
    s_add_u32 m0, s13, 114688
    s_nop 0
    buffer_load_dwordx4 v22, s[40:43], s5 offen lds
    s_add_u32 m0, s13, 115712
    s_nop 0
    buffer_load_dwordx4 v23, s[40:43], s5 offen lds
    s_add_u32 s5, s5, 14336
    s_add_u32 m0, s13, 116736
    s_nop 0
    buffer_load_dwordx4 v22, s[40:43], s5 offen lds
    s_add_u32 m0, s13, 117760
    s_nop 0
    buffer_load_dwordx4 v23, s[40:43], s5 offen lds
    s_bfe_u32 s4, s100, 262160
    s_lshl_b32 s4, s4, 14
    s_add_u32 s4, s4, s82
    s_add_u32 s4, s4, 4096
    s_add_u32 m0, s13, 147456
    s_nop 0
    buffer_load_dwordx4 v2, s[36:39], s4 offen offset:0 lds
    buffer_load_dwordx4 v2, s[36:39], s4 offen offset:1024 lds
    buffer_load_dwordx4 v2, s[36:39], s4 offen offset:2048 lds
    buffer_load_dwordx4 v2, s[36:39], s4 offen offset:3072 lds
    s_waitcnt vmcnt(24)
    s_barrier
    s_bfe_u32 s5, s100, 262160
    s_mul_i32 s5, s5, 229376
    s_add_u32 s5, s5, s83
    s_add_u32 s5, s5, 57344
    s_add_u32 m0, s13, 65536
    s_nop 0
    buffer_load_dwordx4 v22, s[40:43], s5 offen lds
    s_add_u32 m0, s13, 66560
    s_nop 0
    buffer_load_dwordx4 v23, s[40:43], s5 offen lds
    s_add_u32 s5, s5, 14336
    s_add_u32 m0, s13, 67584
    s_nop 0
    buffer_load_dwordx4 v22, s[40:43], s5 offen lds
    s_add_u32 m0, s13, 68608
    s_nop 0
    buffer_load_dwordx4 v23, s[40:43], s5 offen lds
    s_bfe_u32 s4, s100, 262164
    s_lshl_b32 s4, s4, 14
    s_add_u32 s4, s4, s82
    s_add_u32 s4, s4, 4096
    s_add_u32 m0, s13, 81920
    s_nop 0
    buffer_load_dwordx4 v2, s[36:39], s4 offen offset:0 lds
    buffer_load_dwordx4 v2, s[36:39], s4 offen offset:1024 lds
    buffer_load_dwordx4 v2, s[36:39], s4 offen offset:2048 lds
    buffer_load_dwordx4 v2, s[36:39], s4 offen offset:3072 lds
    s_waitcnt vmcnt(20)
    s_barrier
    s_cmp_lg_u32 s10, 7
    s_cbranch_scc1 NOFLAG_17
    v_mov_b32 v44, s14
    v_mov_b32 v45, s15
    v_lshlrev_b32 v46, 7, v1
    s_add_u32 s77, s89, 65536
    s_mov_b64 exec, 0x3fff
    buffer_store_dwordx2 v[44:45], v46, s[36:39], s77 offen sc1
    s_mov_b64 exec, -1
NOFLAG_17:
    s_bfe_u32 s5, s100, 262164
    s_mul_i32 s5, s5, 229376
    s_add_u32 s5, s5, s83
    s_add_u32 s5, s5, 57344
    s_add_u32 m0, s13, 16384
    s_nop 0
    buffer_load_dwordx4 v22, s[40:43], s5 offen lds
    s_add_u32 m0, s13, 17408
    s_nop 0
    buffer_load_dwordx4 v23, s[40:43], s5 offen lds
    s_add_u32 s5, s5, 14336
    s_add_u32 m0, s13, 18432
    s_nop 0
    buffer_load_dwordx4 v22, s[40:43], s5 offen lds
    s_add_u32 m0, s13, 19456
    s_nop 0
    buffer_load_dwordx4 v23, s[40:43], s5 offen lds
    s_bfe_u32 s4, s100, 262168
    s_lshl_b32 s4, s4, 14
    s_add_u32 s4, s4, s82
    s_add_u32 s4, s4, 4096
    s_add_u32 m0, s13, 131072
    s_nop 0
    buffer_load_dwordx4 v2, s[36:39], s4 offen offset:0 lds
    buffer_load_dwordx4 v2, s[36:39], s4 offen offset:1024 lds
    buffer_load_dwordx4 v2, s[36:39], s4 offen offset:2048 lds
    buffer_load_dwordx4 v2, s[36:39], s4 offen offset:3072 lds
    s_waitcnt vmcnt(20)
    s_barrier
    s_bfe_u32 s5, s100, 262168
    s_mul_i32 s5, s5, 229376
    s_add_u32 s5, s5, s83
    s_add_u32 s5, s5, 57344
    s_add_u32 m0, s13, 98304
    s_nop 0
    buffer_load_dwordx4 v22, s[40:43], s5 offen lds
    s_add_u32 m0, s13, 99328
    s_nop 0
    buffer_load_dwordx4 v23, s[40:43], s5 offen lds
    s_add_u32 s5, s5, 14336
    s_add_u32 m0, s13, 100352
    s_nop 0
    buffer_load_dwordx4 v22, s[40:43], s5 offen lds
    s_add_u32 m0, s13, 101376
    s_nop 0
    buffer_load_dwordx4 v23, s[40:43], s5 offen lds
    s_bfe_u32 s5, s100, 262144
    s_lshl_b32 s5, s5, 7
    s_add_u32 s5, s5, s87
    s_add_u32 m0, s13, 32768
    s_nop 0
    buffer_load_dwordx4 v24, s[28:31], s5 offen lds
    s_add_u32 m0, s13, 33792
    s_nop 0
    buffer_load_dwordx4 v25, s[28:31], s5 offen lds
    s_add_u32 s5, s5, 14336
    s_add_u32 m0, s13, 34816
    s_nop 0
    buffer_load_dwordx4 v24, s[28:31], s5 offen lds
    s_add_u32 m0, s13, 35840
    s_nop 0
    buffer_load_dwordx4 v25, s[28:31], s5 offen lds
    s_add_u32 s77, s3, 65536
    buffer_load_dwordx2 v[26:27], v7, s[36:39], s77 offen sc1
    s_waitcnt vmcnt(21)
    s_barrier
    s_bfe_u32 s5, s100, 262148
    s_lshl_b32 s5, s5, 7
    s_add_u32 s5, s5, s87
    s_add_u32 m0, s13, 49152
    s_nop 0
    buffer_load_dwordx4 v24, s[28:31], s5 offen lds
    s_add_u32 m0, s13, 50176
    s_nop 0
    buffer_load_dwordx4 v25, s[28:31], s5 offen lds
    s_add_u32 s5, s5, 14336
    s_add_u32 m0, s13, 51200
    s_nop 0
    buffer_load_dwordx4 v24, s[28:31], s5 offen lds
    s_add_u32 m0, s13, 52224
    s_nop 0
    buffer_load_dwordx4 v25, s[28:31], s5 offen lds
    s_bfe_u32 s5, s100, 262152
    s_lshl_b32 s5, s5, 7
    s_add_u32 s5, s5, s87
    s_add_u32 m0, s13, 114688
    s_nop 0
    buffer_load_dwordx4 v24, s[28:31], s5 offen lds
    s_add_u32 m0, s13, 115712
    s_nop 0
    buffer_load_dwordx4 v25, s[28:31], s5 offen lds
    s_add_u32 s5, s5, 14336
    s_add_u32 m0, s13, 116736
    s_nop 0
    buffer_load_dwordx4 v24, s[28:31], s5 offen lds
    s_add_u32 m0, s13, 117760
    s_nop 0
    buffer_load_dwordx4 v25, s[28:31], s5 offen lds
    s_waitcnt vmcnt(21)
    s_barrier
    s_waitcnt vmcnt(8)
    s_mov_b32 s88, 0
CHK_18:
    v_cmp_ne_u64 s[72:73], s[14:15], v[26:27]
    s_cmp_eq_u64 s[72:73], 0
    s_cbranch_scc1 CHKD_19
    s_add_u32 s88, s88, 1
    s_cmp_ge_u32 s88, 20000
    s_cbranch_scc1 CHKD_19
    s_sleep 3
    s_add_u32 s77, s3, 65536
    buffer_load_dwordx2 v[26:27], v7, s[36:39], s77 offen sc1
    s_waitcnt vmcnt(0)
    s_branch CHK_18
CHKD_19:
    s_bfe_u32 s4, s100, 262144
    s_lshl_b32 s4, s4, 13
    s_add_u32 s4, s4, s85
    s_add_u32 m0, s13, 147456
    s_nop 0
    buffer_load_dwordx4 v2, s[36:39], s4 offen offset:0 lds
    buffer_load_dwordx4 v2, s[36:39], s4 offen offset:1024 lds
    buffer_load_dwordx4 v2, s[36:39], s4 offen offset:2048 lds
    buffer_load_dwordx4 v2, s[36:39], s4 offen offset:3072 lds
    s_bfe_u32 s4, s100, 262148
    s_lshl_b32 s4, s4, 13
    s_add_u32 s4, s4, s85
    s_add_u32 m0, s13, 65536
    s_nop 0
    buffer_load_dwordx4 v2, s[36:39], s4 offen offset:0 lds
    buffer_load_dwordx4 v2, s[36:39], s4 offen offset:1024 lds
    buffer_load_dwordx4 v2, s[36:39], s4 offen offset:2048 lds
    buffer_load_dwordx4 v2, s[36:39], s4 offen offset:3072 lds
    s_bfe_u32 s4, s100, 262152
    s_lshl_b32 s4, s4, 13
    s_add_u32 s4, s4, s85
    s_add_u32 m0, s13, 0
    s_nop 0
    buffer_load_dwordx4 v2, s[36:39], s4 offen offset:0 lds
    buffer_load_dwordx4 v2, s[36:39], s4 offen offset:1024 lds
    buffer_load_dwordx4 v2, s[36:39], s4 offen offset:2048 lds
    buffer_load_dwordx4 v2, s[36:39], s4 offen offset:3072 lds
    s_barrier
    s_bfe_u32 s4, s100, 262156
    s_lshl_b32 s4, s4, 13
    s_add_u32 s4, s4, s85
    s_add_u32 m0, s13, 81920
    s_nop 0
    buffer_load_dwordx4 v2, s[36:39], s4 offen offset:0 lds
    buffer_load_dwordx4 v2, s[36:39], s4 offen offset:1024 lds
    buffer_load_dwordx4 v2, s[36:39], s4 offen offset:2048 lds
    buffer_load_dwordx4 v2, s[36:39], s4 offen offset:3072 lds
    s_bfe_u32 s5, s100, 262156
    s_lshl_b32 s5, s5, 7
    s_add_u32 s5, s5, s87
    s_add_u32 m0, s13, 16384
    s_nop 0
    buffer_load_dwordx4 v24, s[28:31], s5 offen lds
    s_add_u32 m0, s13, 17408
    s_nop 0
    buffer_load_dwordx4 v25, s[28:31], s5 offen lds
    s_add_u32 s5, s5, 14336
    s_add_u32 m0, s13, 18432
    s_nop 0
    buffer_load_dwordx4 v24, s[28:31], s5 offen lds
    s_add_u32 m0, s13, 19456
    s_nop 0
    buffer_load_dwordx4 v25, s[28:31], s5 offen lds
    s_waitcnt vmcnt(16)
    s_barrier
    s_bfe_u32 s4, s100, 262160
    s_lshl_b32 s4, s4, 13
    s_add_u32 s4, s4, s85
    s_add_u32 m0, s13, 131072
    s_nop 0
    buffer_load_dwordx4 v2, s[36:39], s4 offen offset:0 lds
    buffer_load_dwordx4 v2, s[36:39], s4 offen offset:1024 lds
    buffer_load_dwordx4 v2, s[36:39], s4 offen offset:2048 lds
    buffer_load_dwordx4 v2, s[36:39], s4 offen offset:3072 lds
    s_bfe_u32 s5, s100, 262160
    s_lshl_b32 s5, s5, 7
    s_add_u32 s5, s5, s87
    s_add_u32 m0, s13, 98304
    s_nop 0
    buffer_load_dwordx4 v24, s[28:31], s5 offen lds
    s_add_u32 m0, s13, 99328
    s_nop 0
    buffer_load_dwordx4 v25, s[28:31], s5 offen lds
    s_add_u32 s5, s5, 14336
    s_add_u32 m0, s13, 100352
    s_nop 0
    buffer_load_dwordx4 v24, s[28:31], s5 offen lds
    s_add_u32 m0, s13, 101376
    s_nop 0
    buffer_load_dwordx4 v25, s[28:31], s5 offen lds
    s_waitcnt vmcnt(20)
    s_barrier
    s_bfe_u32 s4, s100, 262164
    s_lshl_b32 s4, s4, 13
    s_add_u32 s4, s4, s85
    s_add_u32 m0, s13, 147456
    s_nop 0
    buffer_load_dwordx4 v2, s[36:39], s4 offen offset:0 lds
    buffer_load_dwordx4 v2, s[36:39], s4 offen offset:1024 lds
    buffer_load_dwordx4 v2, s[36:39], s4 offen offset:2048 lds
    buffer_load_dwordx4 v2, s[36:39], s4 offen offset:3072 lds
    s_bfe_u32 s5, s100, 262164
    s_lshl_b32 s5, s5, 7
    s_add_u32 s5, s5, s87
    s_add_u32 m0, s13, 32768
    s_nop 0
    buffer_load_dwordx4 v24, s[28:31], s5 offen lds
    s_add_u32 m0, s13, 33792
    s_nop 0
    buffer_load_dwordx4 v25, s[28:31], s5 offen lds
    s_add_u32 s5, s5, 14336
    s_add_u32 m0, s13, 34816
    s_nop 0
    buffer_load_dwordx4 v24, s[28:31], s5 offen lds
    s_add_u32 m0, s13, 35840
    s_nop 0
    buffer_load_dwordx4 v25, s[28:31], s5 offen lds
    s_waitcnt vmcnt(24)
    s_barrier
    s_bfe_u32 s4, s100, 262168
    s_lshl_b32 s4, s4, 13
    s_add_u32 s4, s4, s85
    s_add_u32 m0, s13, 65536
    s_nop 0
    buffer_load_dwordx4 v2, s[36:39], s4 offen offset:0 lds
    buffer_load_dwordx4 v2, s[36:39], s4 offen offset:1024 lds
    buffer_load_dwordx4 v2, s[36:39], s4 offen offset:2048 lds
    buffer_load_dwordx4 v2, s[36:39], s4 offen offset:3072 lds
    s_bfe_u32 s5, s100, 262168
    s_lshl_b32 s5, s5, 7
    s_add_u32 s5, s5, s87
    s_add_u32 m0, s13, 49152
    s_nop 0
    buffer_load_dwordx4 v24, s[28:31], s5 offen lds
    s_add_u32 m0, s13, 50176
    s_nop 0
    buffer_load_dwordx4 v25, s[28:31], s5 offen lds
    s_add_u32 s5, s5, 14336
    s_add_u32 m0, s13, 51200
    s_nop 0
    buffer_load_dwordx4 v24, s[28:31], s5 offen lds
    s_add_u32 m0, s13, 52224
    s_nop 0
    buffer_load_dwordx4 v25, s[28:31], s5 offen lds
    s_waitcnt vmcnt(24)
    s_barrier
    s_waitcnt vmcnt(16)
    s_barrier
    s_waitcnt vmcnt(8)
    s_barrier
    s_waitcnt vmcnt(0)
    s_barrier
    s_branch L_END
L_COMPUTE:
    s_and_b32 s13, s11, 1
    s_lshr_b32 s2, s11, 1
    v_and_b32 v20, 3, v1
    v_bfe_u32 v21, v1, 2, 1
    v_bfe_u32 v22, v1, 3, 2
    v_lshl_or_b32 v20, v21, 4, v20
    v_lshl_or_b32 v20, v22, 2, v20
    v_bfe_u32 v21, v20, 1, 3
    v_xor_b32 v21, v21, v6
    s_lshl_b32 s72, s13, 6
    v_add_u32 v22, s72, v20
    v_lshlrev_b32 v22, 7, v22
    v_add_u32 v22, 16384, v22
    v_xor_b32 v23, 0, v21
    v_lshl_add_u32 v8, v23, 4, v22
    v_xor_b32 v23, 2, v21
    v_lshl_add_u32 v9, v23, 4, v22
    v_xor_b32 v23, 4, v21
    v_lshl_add_u32 v10, v23, 4, v22
    v_xor_b32 v23, 6, v21
    v_lshl_add_u32 v11, v23, 4, v22
    v_bfe_u32 v20, v1, 1, 4
    s_lshl_b32 s72, s2, 4
    v_add_u32 v20, s72, v20
    v_and_b32 v21, 1, v1
    v_bfe_u32 v22, v20, 1, 3
    v_xor_b32 v22, v22, v21
    v_xor_b32 v22, v22, v6
    v_lshlrev_b32 v23, 7, v20
    v_lshl_add_u32 v23, v21, 12, v23
    v_add_u32 v23, 147456, v23
    v_xor_b32 v24, 0, v22
    v_lshl_add_u32 v12, v24, 4, v23
    v_xor_b32 v24, 2, v22
    v_lshl_add_u32 v13, v24, 4, v23
    v_xor_b32 v24, 4, v22
    v_lshl_add_u32 v14, v24, 4, v23
    v_xor_b32 v24, 6, v22
    v_lshl_add_u32 v15, v24, 4, v23
    v_bfe_u32 v20, v1, 4, 1
    v_bfe_u32 v21, v1, 2, 2
    v_and_b32 v22, 3, v1
    v_lshlrev_b32 v23, 1, v20
    v_lshrrev_b32 v24, 1, v21
    v_xor_b32 v23, v23, v24
    v_lshl_add_u32 v24, v6, 3, v21
    v_lshlrev_b32 v24, 7, v24
    v_lshl_add_u32 v24, v20, 13, v24
    v_and_b32 v25, 1, v22
    v_lshrrev_b32 v22, 1, v22
    v_lshl_or_b32 v22, v25, 1, v22
    v_lshl_add_u32 v24, v22, 3, v24
    v_add_u32 v24, 32768, v24
    s_lshl_b32 s72, s2, 1
    v_xor_b32 v23, s72, v23
    v_lshl_add_u32 v16, v23, 5, v24
    v_xor_b32 v23, 1, v23
    v_lshl_add_u32 v17, v23, 5, v24
    s_lshl_b32 s72, s13, 10
    v_lshl_add_u32 v128, v1, 3, s72
    s_lshl_b32 s72, s2, 10
    v_lshl_add_u32 v129, v1, 3, s72
    v_lshl_add_u32 v134, v5, 5, s72
    s_lshl_b32 s72, s2, 9
    v_lshl_add_u32 v130, v1, 3, s72
    v_lshl_add_u32 v132, v5, 2, s72
    s_lshl_b32 s73, s13, 8
    v_lshl_add_u32 v131, v5, 2, s73
    v_lshl_add_u32 v133, v6, 6, s73
    s_lshl_b32 s73, s13, 4
    v_add_u32 v134, s73, v134
    v_lshl_add_u32 v134, v6, 2, v134
    s_lshl_b32 s72, s6, 2
    s_lshl_b32 s73, s13, 1
    s_add_u32 s72, s72, s73
    s_mul_i32 s72, s72, 168
    s_lshl_b32 s73, s7, 3
    s_add_u32 s72, s72, s73
    s_lshl_b32 s73, s2, 1
    s_add_u32 s72, s72, s73
    s_lshl_b32 s71, s72, 10
    s_waitcnt lgkmcnt(0)
    v_accvgpr_write_b32 a42, 0
    v_accvgpr_write_b32 a43, 0
    v_accvgpr_write_b32 a46, 0
    v_accvgpr_write_b32 a47, 0
    v_accvgpr_write_b32 a50, 0
    v_accvgpr_write_b32 a51, 0
    v_accvgpr_write_b32 a54, 0
    v_accvgpr_write_b32 a55, 0
    v_accvgpr_write_b32 a58, 0
    v_accvgpr_write_b32 a59, 0
    s_barrier
    ds_read_b128 a[0:3], v8
    ds_read_b128 a[4:7], v8 offset:4096
    ds_read_b64_tr_b16 a[12:13], v16 offset:0
    ds_read_b64_tr_b16 a[14:15], v16 offset:512
    ds_read_b128 a[8:11], v12
    ds_read_b64_tr_b16 a[16:17], v17 offset:0
    ds_read_b64_tr_b16 a[18:19], v17 offset:512
    ds_read_b128 a[20:23], v9
    ds_read_b128 a[24:27], v9 offset:4096
    ds_read_b64_tr_b16 a[32:33], v16 offset:2048
    ds_read_b64_tr_b16 a[34:35], v16 offset:2560
    ds_read_b128 a[28:31], v13
    ds_read_b64_tr_b16 a[36:37], v17 offset:2048
    ds_read_b64_tr_b16 a[38:39], v17 offset:2560
    s_waitcnt lgkmcnt(7)
    v_mfma_f32_32x32x16_bf16 v[64:79], a[12:15], a[0:3], 0
    ds_read_b128 v[172:175], v10
    ds_read_b128 v[176:179], v10 offset:4096
    v_mfma_f32_32x32x16_bf16 v[80:95], a[12:15], a[4:7], 0
    ds_read_b64_tr_b16 v[184:185], v16 offset:4096
    ds_read_b64_tr_b16 v[186:187], v16 offset:4608
    v_mfma_f32_32x32x16_bf16 v[32:47], a[0:3], a[8:11], 0
    ds_read_b128 v[180:183], v14
    ds_read_b64_tr_b16 v[188:189], v17 offset:4096
    v_mfma_f32_32x32x16_bf16 v[48:63], a[4:7], a[8:11], 0
    ds_read_b64_tr_b16 v[190:191], v17 offset:4608
    v_mfma_f32_32x32x16_bf16 v[96:111], a[16:19], a[0:3], 0
    v_mfma_f32_32x32x16_bf16 v[112:127], a[16:19], a[4:7], 0
    s_waitcnt lgkmcnt(7)
    v_mfma_f32_32x32x16_bf16 v[64:79], a[32:35], a[20:23], v[64:79]
    ds_read_b128 a[0:3], v11
    ds_read_b128 a[4:7], v11 offset:4096
    v_mfma_f32_32x32x16_bf16 v[80:95], a[32:35], a[24:27], v[80:95]
    ds_read_b64_tr_b16 a[12:13], v16 offset:6144
    ds_read_b64_tr_b16 a[14:15], v16 offset:6656
    v_mfma_f32_32x32x16_bf16 v[32:47], a[20:23], a[28:31], v[32:47]
    ds_read_b128 a[8:11], v15
    ds_read_b64_tr_b16 a[16:17], v17 offset:6144
    v_mfma_f32_32x32x16_bf16 v[48:63], a[24:27], a[28:31], v[48:63]
    ds_read_b64_tr_b16 a[18:19], v17 offset:6656
    v_mfma_f32_32x32x16_bf16 v[96:111], a[36:39], a[20:23], v[96:111]
    v_mfma_f32_32x32x16_bf16 v[112:127], a[36:39], a[24:27], v[112:127]
    s_waitcnt lgkmcnt(7)
    v_mfma_f32_32x32x16_bf16 v[64:79], v[184:187], v[172:175], v[64:79]
    v_mfma_f32_32x32x16_bf16 v[80:95], v[184:187], v[176:179], v[80:95]
    v_mfma_f32_32x32x16_bf16 v[32:47], v[172:175], v[180:183], v[32:47]
    s_waitcnt lgkmcnt(0)
    s_barrier
    v_add_u32 v8, 32768, v8
    v_add_u32 v9, 32768, v9
    v_add_u32 v10, 32768, v10
    v_add_u32 v11, 32768, v11
    v_add_u32 v16, 32768, v16
    v_add_u32 v17, 32768, v17
    v_add_u32 v12, 8192, v12
    v_add_u32 v13, 8192, v13
    v_add_u32 v14, 8192, v14
    v_add_u32 v15, 8192, v15
    ds_read_b128 a[20:23], v8
    ds_read_b128 a[24:27], v8 offset:4096
    ds_read_b64_tr_b16 a[32:33], v16 offset:0
    v_mfma_f32_32x32x16_bf16 v[48:63], v[176:179], v[180:183], v[48:63]
    ds_read_b64_tr_b16 a[34:35], v16 offset:512
    ds_read_b128 a[28:31], v12
    ds_read_b64_tr_b16 a[36:37], v17 offset:0
    v_mfma_f32_32x32x16_bf16 v[96:111], v[188:191], v[172:175], v[96:111]
    ds_read_b64_tr_b16 a[38:39], v17 offset:512
    v_mfma_f32_32x32x16_bf16 v[112:127], v[188:191], v[176:179], v[112:127]
    v_mfma_f32_32x32x16_bf16 v[64:79], a[12:15], a[0:3], v[64:79]
    ds_read_b128 v[172:175], v9
    ds_read_b128 v[176:179], v9 offset:4096
    v_mfma_f32_32x32x16_bf16 v[80:95], a[12:15], a[4:7], v[80:95]
    ds_read_b64_tr_b16 v[184:185], v16 offset:2048
    ds_read_b64_tr_b16 v[186:187], v16 offset:2560
    v_mfma_f32_32x32x16_bf16 v[32:47], a[0:3], a[8:11], v[32:47]
    ds_read_b128 v[180:183], v13
    ds_read_b64_tr_b16 v[188:189], v17 offset:2048
    v_mfma_f32_32x32x16_bf16 v[48:63], a[4:7], a[8:11], v[48:63]
    ds_read_b64_tr_b16 v[190:191], v17 offset:2560
    v_mfma_f32_32x32x16_bf16 v[96:111], a[16:19], a[0:3], v[96:111]
    v_mfma_f32_32x32x16_bf16 v[112:127], a[16:19], a[4:7], v[112:127]
    s_waitcnt lgkmcnt(7)
    v_mfma_f32_32x32x16_bf16 v[64:79], a[32:35], a[20:23], v[64:79]
    ds_read_b128 a[0:3], v10
    ds_read_b128 a[4:7], v10 offset:4096
    v_mfma_f32_32x32x16_bf16 v[80:95], a[32:35], a[24:27], v[80:95]
    ds_read_b64_tr_b16 a[12:13], v16 offset:4096
    ds_read_b64_tr_b16 a[14:15], v16 offset:4608
    v_mfma_f32_32x32x16_bf16 v[32:47], a[20:23], a[28:31], v[32:47]
    ds_read_b128 a[8:11], v14
    ds_read_b64_tr_b16 a[16:17], v17 offset:4096
    v_mfma_f32_32x32x16_bf16 v[48:63], a[24:27], a[28:31], v[48:63]
    ds_read_b64_tr_b16 a[18:19], v17 offset:4608
    v_mfma_f32_32x32x16_bf16 v[96:111], a[36:39], a[20:23], v[96:111]
    v_mfma_f32_32x32x16_bf16 v[112:127], a[36:39], a[24:27], v[112:127]
    s_waitcnt lgkmcnt(7)
    v_mfma_f32_32x32x16_bf16 v[64:79], v[184:187], v[172:175], v[64:79]
    ds_read_b128 a[20:23], v11
    ds_read_b128 a[24:27], v11 offset:4096
    v_mfma_f32_32x32x16_bf16 v[80:95], v[184:187], v[176:179], v[80:95]
    ds_read_b64_tr_b16 a[32:33], v16 offset:6144
    ds_read_b64_tr_b16 a[34:35], v16 offset:6656
    v_mfma_f32_32x32x16_bf16 v[32:47], v[172:175], v[180:183], v[32:47]
    ds_read_b128 a[28:31], v15
    ds_read_b64_tr_b16 a[36:37], v17 offset:6144
    v_mfma_f32_32x32x16_bf16 v[48:63], v[176:179], v[180:183], v[48:63]
    ds_read_b64_tr_b16 a[38:39], v17 offset:6656
    v_mfma_f32_32x32x16_bf16 v[96:111], v[188:191], v[172:175], v[96:111]
    v_mfma_f32_32x32x16_bf16 v[112:127], v[188:191], v[176:179], v[112:127]
    s_waitcnt lgkmcnt(7)
    v_mfma_f32_32x32x16_bf16 v[64:79], a[12:15], a[0:3], v[64:79]
    v_mfma_f32_32x32x16_bf16 v[80:95], a[12:15], a[4:7], v[80:95]
    v_mfma_f32_32x32x16_bf16 v[32:47], a[0:3], a[8:11], v[32:47]
    s_waitcnt lgkmcnt(0)
    s_barrier
    v_add_u32 v8, 32768, v8
    v_add_u32 v9, 32768, v9
    v_add_u32 v10, 32768, v10
    v_add_u32 v11, 32768, v11
    v_add_u32 v16, 32768, v16
    v_add_u32 v17, 32768, v17
    v_add_u32 v12, 4294959104, v12
    v_add_u32 v13, 4294959104, v13
    v_add_u32 v14, 4294959104, v14
    v_add_u32 v15, 4294959104, v15
    ds_read_b128 v[172:175], v8
    ds_read_b128 v[176:179], v8 offset:4096
    ds_read_b64_tr_b16 v[184:185], v16 offset:0
    v_mfma_f32_32x32x16_bf16 v[48:63], a[4:7], a[8:11], v[48:63]
    ds_read_b64_tr_b16 v[186:187], v16 offset:512
    ds_read_b128 v[180:183], v12
    ds_read_b64_tr_b16 v[188:189], v17 offset:0
    v_mfma_f32_32x32x16_bf16 v[96:111], a[16:19], a[0:3], v[96:111]
    ds_read_b64_tr_b16 v[190:191], v17 offset:512
    v_mfma_f32_32x32x16_bf16 v[112:127], a[16:19], a[4:7], v[112:127]
    v_mfma_f32_32x32x16_bf16 v[64:79], a[32:35], a[20:23], v[64:79]
    ds_read_b128 a[0:3], v9
    ds_read_b128 a[4:7], v9 offset:4096
    v_mfma_f32_32x32x16_bf16 v[80:95], a[32:35], a[24:27], v[80:95]
    ds_read_b64_tr_b16 a[12:13], v16 offset:2048
    ds_read_b64_tr_b16 a[14:15], v16 offset:2560
    v_mfma_f32_32x32x16_bf16 v[32:47], a[20:23], a[28:31], v[32:47]
    ds_read_b128 a[8:11], v13
    ds_read_b64_tr_b16 a[16:17], v17 offset:2048
    v_mfma_f32_32x32x16_bf16 v[48:63], a[24:27], a[28:31], v[48:63]
    ds_read_b64_tr_b16 a[18:19], v17 offset:2560
    v_mfma_f32_32x32x16_bf16 v[96:111], a[36:39], a[20:23], v[96:111]
    v_mfma_f32_32x32x16_bf16 v[112:127], a[36:39], a[24:27], v[112:127]
    s_waitcnt lgkmcnt(7)
    v_mfma_f32_32x32x16_bf16 v[64:79], v[184:187], v[172:175], v[64:79]
    ds_read_b128 a[20:23], v10
    ds_read_b128 a[24:27], v10 offset:4096
    v_mfma_f32_32x32x16_bf16 v[80:95], v[184:187], v[176:179], v[80:95]
    ds_read_b64_tr_b16 a[32:33], v16 offset:4096
    ds_read_b64_tr_b16 a[34:35], v16 offset:4608
    v_mfma_f32_32x32x16_bf16 v[32:47], v[172:175], v[180:183], v[32:47]
    ds_read_b128 a[28:31], v14
    ds_read_b64_tr_b16 a[36:37], v17 offset:4096
    v_mfma_f32_32x32x16_bf16 v[48:63], v[176:179], v[180:183], v[48:63]
    ds_read_b64_tr_b16 a[38:39], v17 offset:4608
    v_mfma_f32_32x32x16_bf16 v[96:111], v[188:191], v[172:175], v[96:111]
    v_mfma_f32_32x32x16_bf16 v[112:127], v[188:191], v[176:179], v[112:127]
    s_waitcnt lgkmcnt(7)
    v_mfma_f32_32x32x16_bf16 v[64:79], a[12:15], a[0:3], v[64:79]
    ds_read_b128 v[172:175], v11
    ds_read_b128 v[176:179], v11 offset:4096
    v_mfma_f32_32x32x16_bf16 v[80:95], a[12:15], a[4:7], v[80:95]
    ds_read_b64_tr_b16 v[184:185], v16 offset:6144
    ds_read_b64_tr_b16 v[186:187], v16 offset:6656
    v_mfma_f32_32x32x16_bf16 v[32:47], a[0:3], a[8:11], v[32:47]
    ds_read_b128 v[180:183], v15
    ds_read_b64_tr_b16 v[188:189], v17 offset:6144
    v_mfma_f32_32x32x16_bf16 v[48:63], a[4:7], a[8:11], v[48:63]
    ds_read_b64_tr_b16 v[190:191], v17 offset:6656
    v_mfma_f32_32x32x16_bf16 v[96:111], a[16:19], a[0:3], v[96:111]
    v_mfma_f32_32x32x16_bf16 v[112:127], a[16:19], a[4:7], v[112:127]
    s_waitcnt lgkmcnt(7)
    v_mfma_f32_32x32x16_bf16 v[64:79], a[32:35], a[20:23], v[64:79]
    v_mfma_f32_32x32x16_bf16 v[80:95], a[32:35], a[24:27], v[80:95]
    v_mfma_f32_32x32x16_bf16 v[32:47], a[20:23], a[28:31], v[32:47]
    s_waitcnt lgkmcnt(0)
    s_barrier
    v_add_u32 v8, 32768, v8
    v_add_u32 v9, 32768, v9
    v_add_u32 v10, 32768, v10
    v_add_u32 v11, 32768, v11
    v_add_u32 v16, 32768, v16
    v_add_u32 v17, 32768, v17
    v_add_u32 v12, 8192, v12
    v_add_u32 v13, 8192, v13
    v_add_u32 v14, 8192, v14
    v_add_u32 v15, 8192, v15
    ds_read_b128 a[0:3], v8
    ds_read_b128 a[4:7], v8 offset:4096
    ds_read_b64_tr_b16 a[12:13], v16 offset:0
    v_mfma_f32_32x32x16_bf16 v[48:63], a[24:27], a[28:31], v[48:63]
    ds_read_b64_tr_b16 a[14:15], v16 offset:512
    ds_read_b128 a[8:11], v12
    ds_read_b64_tr_b16 a[16:17], v17 offset:0
    v_mfma_f32_32x32x16_bf16 v[96:111], a[36:39], a[20:23], v[96:111]
    ds_read_b64_tr_b16 a[18:19], v17 offset:512
    v_mfma_f32_32x32x16_bf16 v[112:127], a[36:39], a[24:27], v[112:127]
    v_mfma_f32_32x32x16_bf16 v[64:79], v[184:187], v[172:175], v[64:79]
    ds_read_b128 a[20:23], v9
    ds_read_b128 a[24:27], v9 offset:4096
    v_mfma_f32_32x32x16_bf16 v[80:95], v[184:187], v[176:179], v[80:95]
    ds_read_b64_tr_b16 a[32:33], v16 offset:2048
    ds_read_b64_tr_b16 a[34:35], v16 offset:2560
    v_mfma_f32_32x32x16_bf16 v[32:47], v[172:175], v[180:183], v[32:47]
    ds_read_b128 a[28:31], v13
    ds_read_b64_tr_b16 a[36:37], v17 offset:2048
    v_mfma_f32_32x32x16_bf16 v[48:63], v[176:179], v[180:183], v[48:63]
    ds_read_b64_tr_b16 a[38:39], v17 offset:2560
    v_mfma_f32_32x32x16_bf16 v[96:111], v[188:191], v[172:175], v[96:111]
    v_mfma_f32_32x32x16_bf16 v[112:127], v[188:191], v[176:179], v[112:127]
    s_waitcnt lgkmcnt(7)
    v_mfma_f32_32x32x16_bf16 v[64:79], a[12:15], a[0:3], v[64:79]
    ds_read_b128 v[172:175], v10
    ds_read_b128 v[176:179], v10 offset:4096
    v_mfma_f32_32x32x16_bf16 v[80:95], a[12:15], a[4:7], v[80:95]
    ds_read_b64_tr_b16 v[184:185], v16 offset:4096
    ds_read_b64_tr_b16 v[186:187], v16 offset:4608
    v_mfma_f32_32x32x16_bf16 v[32:47], a[0:3], a[8:11], v[32:47]
    ds_read_b128 v[180:183], v14
    ds_read_b64_tr_b16 v[188:189], v17 offset:4096
    v_mfma_f32_32x32x16_bf16 v[48:63], a[4:7], a[8:11], v[48:63]
    ds_read_b64_tr_b16 v[190:191], v17 offset:4608
    v_mfma_f32_32x32x16_bf16 v[96:111], a[16:19], a[0:3], v[96:111]
    v_mfma_f32_32x32x16_bf16 v[112:127], a[16:19], a[4:7], v[112:127]
    s_waitcnt lgkmcnt(7)
    v_mfma_f32_32x32x16_bf16 v[64:79], a[32:35], a[20:23], v[64:79]
    ds_read_b128 a[0:3], v11
    ds_read_b128 a[4:7], v11 offset:4096
    v_mfma_f32_32x32x16_bf16 v[80:95], a[32:35], a[24:27], v[80:95]
    ds_read_b64_tr_b16 a[12:13], v16 offset:6144
    ds_read_b64_tr_b16 a[14:15], v16 offset:6656
    v_mfma_f32_32x32x16_bf16 v[32:47], a[20:23], a[28:31], v[32:47]
    ds_read_b128 a[8:11], v15
    ds_read_b64_tr_b16 a[16:17], v17 offset:6144
    v_mfma_f32_32x32x16_bf16 v[48:63], a[24:27], a[28:31], v[48:63]
    ds_read_b64_tr_b16 a[18:19], v17 offset:6656
    v_mfma_f32_32x32x16_bf16 v[96:111], a[36:39], a[20:23], v[96:111]
    v_mfma_f32_32x32x16_bf16 v[112:127], a[36:39], a[24:27], v[112:127]
    s_waitcnt lgkmcnt(7)
    v_mfma_f32_32x32x16_bf16 v[64:79], v[184:187], v[172:175], v[64:79]
    v_mfma_f32_32x32x16_bf16 v[80:95], v[184:187], v[176:179], v[80:95]
    v_mfma_f32_32x32x16_bf16 v[32:47], v[172:175], v[180:183], v[32:47]
    s_waitcnt lgkmcnt(0)
    s_barrier
    v_add_u32 v8, 4294868992, v8
    v_add_u32 v9, 4294868992, v9
    v_add_u32 v10, 4294868992, v10
    v_add_u32 v11, 4294868992, v11
    v_add_u32 v16, 4294868992, v16
    v_add_u32 v17, 4294868992, v17
    v_add_u32 v12, 4294959104, v12
    v_add_u32 v13, 4294959104, v13
    v_add_u32 v14, 4294959104, v14
    v_add_u32 v15, 4294959104, v15
    ds_read_b128 a[20:23], v8
    ds_read_b128 a[24:27], v8 offset:4096
    ds_read_b64_tr_b16 a[32:33], v16 offset:0
    v_mfma_f32_32x32x16_bf16 v[48:63], v[176:179], v[180:183], v[48:63]
    ds_read_b64_tr_b16 a[34:35], v16 offset:512
    ds_read_b128 a[28:31], v12
    ds_read_b64_tr_b16 a[36:37], v17 offset:0
    v_mfma_f32_32x32x16_bf16 v[96:111], v[188:191], v[172:175], v[96:111]
    ds_read_b64_tr_b16 a[38:39], v17 offset:512
    v_mfma_f32_32x32x16_bf16 v[112:127], v[188:191], v[176:179], v[112:127]
    v_mfma_f32_32x32x16_bf16 v[64:79], a[12:15], a[0:3], v[64:79]
    ds_read_b128 v[172:175], v9
    ds_read_b128 v[176:179], v9 offset:4096
    v_mfma_f32_32x32x16_bf16 v[80:95], a[12:15], a[4:7], v[80:95]
    ds_read_b64_tr_b16 v[184:185], v16 offset:2048
    ds_read_b64_tr_b16 v[186:187], v16 offset:2560
    v_mfma_f32_32x32x16_bf16 v[32:47], a[0:3], a[8:11], v[32:47]
    ds_read_b128 v[180:183], v13
    ds_read_b64_tr_b16 v[188:189], v17 offset:2048
    v_mfma_f32_32x32x16_bf16 v[48:63], a[4:7], a[8:11], v[48:63]
    ds_read_b64_tr_b16 v[190:191], v17 offset:2560
    v_mfma_f32_32x32x16_bf16 v[96:111], a[16:19], a[0:3], v[96:111]
    v_mfma_f32_32x32x16_bf16 v[112:127], a[16:19], a[4:7], v[112:127]
    s_waitcnt lgkmcnt(7)
    v_mfma_f32_32x32x16_bf16 v[64:79], a[32:35], a[20:23], v[64:79]
    ds_read_b128 a[0:3], v10
    ds_read_b128 a[4:7], v10 offset:4096
    v_mfma_f32_32x32x16_bf16 v[80:95], a[32:35], a[24:27], v[80:95]
    ds_read_b64_tr_b16 a[12:13], v16 offset:4096
    ds_read_b64_tr_b16 a[14:15], v16 offset:4608
    v_mfma_f32_32x32x16_bf16 v[32:47], a[20:23], a[28:31], v[32:47]
    ds_read_b128 a[8:11], v14
    ds_read_b64_tr_b16 a[16:17], v17 offset:4096
    v_mfma_f32_32x32x16_bf16 v[48:63], a[24:27], a[28:31], v[48:63]
    ds_read_b64_tr_b16 a[18:19], v17 offset:4608
    v_mfma_f32_32x32x16_bf16 v[96:111], a[36:39], a[20:23], v[96:111]
    v_mfma_f32_32x32x16_bf16 v[112:127], a[36:39], a[24:27], v[112:127]
    s_waitcnt lgkmcnt(7)
    v_mfma_f32_32x32x16_bf16 v[64:79], v[184:187], v[172:175], v[64:79]
    ds_read_b128 a[20:23], v11
    ds_read_b128 a[24:27], v11 offset:4096
    v_mfma_f32_32x32x16_bf16 v[80:95], v[184:187], v[176:179], v[80:95]
    ds_read_b64_tr_b16 a[32:33], v16 offset:6144
    ds_read_b64_tr_b16 a[34:35], v16 offset:6656
    v_mfma_f32_32x32x16_bf16 v[32:47], v[172:175], v[180:183], v[32:47]
    ds_read_b128 a[28:31], v15
    ds_read_b64_tr_b16 a[36:37], v17 offset:6144
    v_mfma_f32_32x32x16_bf16 v[48:63], v[176:179], v[180:183], v[48:63]
    ds_read_b64_tr_b16 a[38:39], v17 offset:6656
    v_mfma_f32_32x32x16_bf16 v[96:111], v[188:191], v[172:175], v[96:111]
    v_mfma_f32_32x32x16_bf16 v[112:127], v[188:191], v[176:179], v[112:127]
    s_waitcnt lgkmcnt(7)
    v_mfma_f32_32x32x16_bf16 v[64:79], a[12:15], a[0:3], v[64:79]
    v_mfma_f32_32x32x16_bf16 v[80:95], a[12:15], a[4:7], v[80:95]
    v_mfma_f32_32x32x16_bf16 v[32:47], a[0:3], a[8:11], v[32:47]
    s_waitcnt lgkmcnt(0)
    s_barrier
    v_add_u32 v8, 32768, v8
    v_add_u32 v9, 32768, v9
    v_add_u32 v10, 32768, v10
    v_add_u32 v11, 32768, v11
    v_add_u32 v16, 32768, v16
    v_add_u32 v17, 32768, v17
    v_add_u32 v12, 8192, v12
    v_add_u32 v13, 8192, v13
    v_add_u32 v14, 8192, v14
    v_add_u32 v15, 8192, v15
    ds_read_b128 v[172:175], v8
    ds_read_b128 v[176:179], v8 offset:4096
    ds_read_b64_tr_b16 v[184:185], v16 offset:0
    v_mfma_f32_32x32x16_bf16 v[48:63], a[4:7], a[8:11], v[48:63]
    ds_read_b64_tr_b16 v[186:187], v16 offset:512
    ds_read_b128 v[180:183], v12
    ds_read_b64_tr_b16 v[188:189], v17 offset:0
    v_mfma_f32_32x32x16_bf16 v[96:111], a[16:19], a[0:3], v[96:111]
    ds_read_b64_tr_b16 v[190:191], v17 offset:512
    v_mfma_f32_32x32x16_bf16 v[112:127], a[16:19], a[4:7], v[112:127]
    v_mfma_f32_32x32x16_bf16 v[64:79], a[32:35], a[20:23], v[64:79]
    ds_read_b128 a[0:3], v9
    ds_read_b128 a[4:7], v9 offset:4096
    v_mfma_f32_32x32x16_bf16 v[80:95], a[32:35], a[24:27], v[80:95]
    ds_read_b64_tr_b16 a[12:13], v16 offset:2048
    ds_read_b64_tr_b16 a[14:15], v16 offset:2560
    v_mfma_f32_32x32x16_bf16 v[32:47], a[20:23], a[28:31], v[32:47]
    ds_read_b128 a[8:11], v13
    ds_read_b64_tr_b16 a[16:17], v17 offset:2048
    v_mfma_f32_32x32x16_bf16 v[48:63], a[24:27], a[28:31], v[48:63]
    ds_read_b64_tr_b16 a[18:19], v17 offset:2560
    v_mfma_f32_32x32x16_bf16 v[96:111], a[36:39], a[20:23], v[96:111]
    v_mfma_f32_32x32x16_bf16 v[112:127], a[36:39], a[24:27], v[112:127]
    s_waitcnt lgkmcnt(7)
    v_mfma_f32_32x32x16_bf16 v[64:79], v[184:187], v[172:175], v[64:79]
    ds_read_b128 a[20:23], v10
    ds_read_b128 a[24:27], v10 offset:4096
    v_mfma_f32_32x32x16_bf16 v[80:95], v[184:187], v[176:179], v[80:95]
    ds_read_b64_tr_b16 a[32:33], v16 offset:4096
    ds_read_b64_tr_b16 a[34:35], v16 offset:4608
    v_mfma_f32_32x32x16_bf16 v[32:47], v[172:175], v[180:183], v[32:47]
    ds_read_b128 a[28:31], v14
    ds_read_b64_tr_b16 a[36:37], v17 offset:4096
    v_mfma_f32_32x32x16_bf16 v[48:63], v[176:179], v[180:183], v[48:63]
    ds_read_b64_tr_b16 a[38:39], v17 offset:4608
    v_mfma_f32_32x32x16_bf16 v[96:111], v[188:191], v[172:175], v[96:111]
    v_mfma_f32_32x32x16_bf16 v[112:127], v[188:191], v[176:179], v[112:127]
    s_waitcnt lgkmcnt(7)
    v_mfma_f32_32x32x16_bf16 v[64:79], a[12:15], a[0:3], v[64:79]
    ds_read_b128 v[172:175], v11
    ds_read_b128 v[176:179], v11 offset:4096
    v_mfma_f32_32x32x16_bf16 v[80:95], a[12:15], a[4:7], v[80:95]
    ds_read_b64_tr_b16 v[184:185], v16 offset:6144
    ds_read_b64_tr_b16 v[186:187], v16 offset:6656
    v_mfma_f32_32x32x16_bf16 v[32:47], a[0:3], a[8:11], v[32:47]
    ds_read_b128 v[180:183], v15
    ds_read_b64_tr_b16 v[188:189], v17 offset:6144
    v_mfma_f32_32x32x16_bf16 v[48:63], a[4:7], a[8:11], v[48:63]
    ds_read_b64_tr_b16 v[190:191], v17 offset:6656
    v_mfma_f32_32x32x16_bf16 v[96:111], a[16:19], a[0:3], v[96:111]
    v_mfma_f32_32x32x16_bf16 v[112:127], a[16:19], a[4:7], v[112:127]
    s_waitcnt lgkmcnt(7)
    v_mfma_f32_32x32x16_bf16 v[64:79], a[32:35], a[20:23], v[64:79]
    v_mfma_f32_32x32x16_bf16 v[80:95], a[32:35], a[24:27], v[80:95]
    v_mfma_f32_32x32x16_bf16 v[32:47], a[20:23], a[28:31], v[32:47]
    s_waitcnt lgkmcnt(0)
    s_barrier
    v_add_u32 v8, 32768, v8
    v_add_u32 v9, 32768, v9
    v_add_u32 v10, 32768, v10
    v_add_u32 v11, 32768, v11
    v_add_u32 v16, 32768, v16
    v_add_u32 v17, 32768, v17
    v_add_u32 v12, 4294959104, v12
    v_add_u32 v13, 4294959104, v13
    v_add_u32 v14, 4294959104, v14
    v_add_u32 v15, 4294959104, v15
    ds_read_b128 a[0:3], v8
    ds_read_b128 a[4:7], v8 offset:4096
    ds_read_b64_tr_b16 a[12:13], v16 offset:0
    v_mfma_f32_32x32x16_bf16 v[48:63], a[24:27], a[28:31], v[48:63]
    ds_read_b64_tr_b16 a[14:15], v16 offset:512
    ds_read_b128 a[8:11], v12
    ds_read_b64_tr_b16 a[16:17], v17 offset:0
    v_mfma_f32_32x32x16_bf16 v[96:111], a[36:39], a[20:23], v[96:111]
    ds_read_b64_tr_b16 a[18:19], v17 offset:512
    v_mfma_f32_32x32x16_bf16 v[112:127], a[36:39], a[24:27], v[112:127]
    v_mfma_f32_32x32x16_bf16 v[64:79], v[184:187], v[172:175], v[64:79]
    ds_read_b128 a[20:23], v9
    ds_read_b128 a[24:27], v9 offset:4096
    v_mfma_f32_32x32x16_bf16 v[80:95], v[184:187], v[176:179], v[80:95]
    ds_read_b64_tr_b16 a[32:33], v16 offset:2048
    ds_read_b64_tr_b16 a[34:35], v16 offset:2560
    v_mfma_f32_32x32x16_bf16 v[32:47], v[172:175], v[180:183], v[32:47]
    ds_read_b128 a[28:31], v13
    ds_read_b64_tr_b16 a[36:37], v17 offset:2048
    v_mfma_f32_32x32x16_bf16 v[48:63], v[176:179], v[180:183], v[48:63]
    ds_read_b64_tr_b16 a[38:39], v17 offset:2560
    v_mfma_f32_32x32x16_bf16 v[96:111], v[188:191], v[172:175], v[96:111]
    v_mfma_f32_32x32x16_bf16 v[112:127], v[188:191], v[176:179], v[112:127]
    s_waitcnt lgkmcnt(7)
    v_mfma_f32_32x32x16_bf16 v[64:79], a[12:15], a[0:3], v[64:79]
    ds_read_b128 v[172:175], v10
    ds_read_b128 v[176:179], v10 offset:4096
    v_mfma_f32_32x32x16_bf16 v[80:95], a[12:15], a[4:7], v[80:95]
    ds_read_b64_tr_b16 v[184:185], v16 offset:4096
    ds_read_b64_tr_b16 v[186:187], v16 offset:4608
    v_mfma_f32_32x32x16_bf16 v[32:47], a[0:3], a[8:11], v[32:47]
    ds_read_b128 v[180:183], v14
    ds_read_b64_tr_b16 v[188:189], v17 offset:4096
    v_mfma_f32_32x32x16_bf16 v[48:63], a[4:7], a[8:11], v[48:63]
    ds_read_b64_tr_b16 v[190:191], v17 offset:4608
    v_mfma_f32_32x32x16_bf16 v[96:111], a[16:19], a[0:3], v[96:111]
    v_mfma_f32_32x32x16_bf16 v[112:127], a[16:19], a[4:7], v[112:127]
    s_waitcnt lgkmcnt(7)
    v_mfma_f32_32x32x16_bf16 v[64:79], a[32:35], a[20:23], v[64:79]
    ds_read_b128 a[0:3], v11
    ds_read_b128 a[4:7], v11 offset:4096
    v_mfma_f32_32x32x16_bf16 v[80:95], a[32:35], a[24:27], v[80:95]
    ds_read_b64_tr_b16 a[12:13], v16 offset:6144
    ds_read_b64_tr_b16 a[14:15], v16 offset:6656
    v_mfma_f32_32x32x16_bf16 v[32:47], a[20:23], a[28:31], v[32:47]
    ds_read_b128 a[8:11], v15
    ds_read_b64_tr_b16 a[16:17], v17 offset:6144
    v_mfma_f32_32x32x16_bf16 v[48:63], a[24:27], a[28:31], v[48:63]
    ds_read_b64_tr_b16 a[18:19], v17 offset:6656
    v_mfma_f32_32x32x16_bf16 v[96:111], a[36:39], a[20:23], v[96:111]
    v_mfma_f32_32x32x16_bf16 v[112:127], a[36:39], a[24:27], v[112:127]
    s_waitcnt lgkmcnt(7)
    v_mfma_f32_32x32x16_bf16 v[64:79], v[184:187], v[172:175], v[64:79]
    v_mfma_f32_32x32x16_bf16 v[80:95], v[184:187], v[176:179], v[80:95]
    v_mfma_f32_32x32x16_bf16 v[32:47], v[172:175], v[180:183], v[32:47]
    s_waitcnt lgkmcnt(0)
    s_barrier
    v_add_u32 v8, 32768, v8
    v_add_u32 v9, 32768, v9
    v_add_u32 v10, 32768, v10
    v_add_u32 v11, 32768, v11
    v_add_u32 v16, 32768, v16
    v_add_u32 v17, 32768, v17
    ds_read_b64 a[52:53], v129 offset:2048
    ds_read_b64 a[56:57], v129 offset:2560
    ds_read_b64 a[40:41], v128 offset:0
    v_mfma_f32_32x32x16_bf16 v[48:63], v[176:179], v[180:183], v[48:63]
    ds_read_b64 a[44:45], v128 offset:512
    ds_read_b64 a[48:49], v130 offset:6144
    ds_read_b32 v18, v131 offset:7168
    v_mfma_f32_32x32x16_bf16 v[96:111], v[188:191], v[172:175], v[96:111]
    ds_read_b32 v19, v131 offset:7296
    ds_read_b32 v136, v132 offset:8192
    ds_read_b32 v137, v132 offset:8320
    v_mfma_f32_32x32x16_bf16 v[112:127], v[188:191], v[176:179], v[112:127]
    ds_read_b32 v138, v132 offset:8448
    ds_read_b32 v139, v132 offset:8576
    v_mfma_f32_32x32x16_bf16 v[64:79], a[12:15], a[0:3], v[64:79]
    v_mfma_f32_32x32x16_bf16 v[80:95], a[12:15], a[4:7], v[80:95]
    v_mfma_f32_32x32x16_bf16 v[32:47], a[0:3], a[8:11], v[32:47]
    v_mfma_f32_32x32x16_bf16 v[48:63], a[4:7], a[8:11], v[48:63]
    v_mfma_f32_32x32x16_bf16 v[96:111], a[16:19], a[0:3], v[96:111]
    v_mfma_f32_32x32x16_bf16 v[112:127], a[16:19], a[4:7], v[112:127]
    s_waitcnt lgkmcnt(0)
    v_mfma_f32_32x32x16_bf16 v[32:47], a[40:43], a[48:51], v[32:47]
    v_mfma_f32_32x32x16_bf16 v[48:63], a[44:47], a[48:51], v[48:63]
    v_mfma_f32_32x32x16_bf16 v[64:79], a[52:55], a[40:43], v[64:79]
    v_mfma_f32_32x32x16_bf16 v[80:95], a[52:55], a[44:47], v[80:95]
    v_mfma_f32_32x32x16_bf16 v[96:111], a[56:59], a[40:43], v[96:111]
    v_mfma_f32_32x32x16_bf16 v[112:127], a[56:59], a[44:47], v[112:127]
    v_mov_b32 v14, v18
    v_mov_b32 v15, v19
    ds_read_b128 v[20:23], v133 offset:7680
    ds_read_b128 v[24:27], v133 offset:7696
    v_rcp_f32 v140, v14
    v_rcp_f32 v141, v15
    v_mul_f32 v142, -1.4426950408889634, v14
    v_mul_f32 v143, -1.4426950408889634, v15
    v_mul_f32 v140, -1.4426950408889634, v140
    v_mul_f32 v141, -1.4426950408889634, v141
    s_nop 3
    s_waitcnt lgkmcnt(1)
    v_pk_mul_f32 v[32:33], v[32:33], v[20:21]
    v_pk_mul_f32 v[34:35], v[34:35], v[22:23]
    ds_read_b128 v[20:23], v133 offset:7712
    s_waitcnt lgkmcnt(1)
    v_pk_mul_f32 v[36:37], v[36:37], v[24:25]
    v_pk_mul_f32 v[38:39], v[38:39], v[26:27]
    ds_read_b128 v[24:27], v133 offset:7728
    s_waitcnt lgkmcnt(1)
    v_pk_mul_f32 v[40:41], v[40:41], v[20:21]
    v_pk_mul_f32 v[42:43], v[42:43], v[22:23]
    ds_read_b128 v[20:23], v133 offset:7808
    s_waitcnt lgkmcnt(1)
    v_pk_mul_f32 v[44:45], v[44:45], v[24:25]
    v_pk_mul_f32 v[46:47], v[46:47], v[26:27]
    ds_read_b128 v[24:27], v133 offset:7824
    s_waitcnt lgkmcnt(1)
    v_pk_mul_f32 v[48:49], v[48:49], v[20:21]
    v_pk_mul_f32 v[50:51], v[50:51], v[22:23]
    ds_read_b128 v[20:23], v133 offset:7840
    s_waitcnt lgkmcnt(1)
    v_pk_mul_f32 v[52:53], v[52:53], v[24:25]
    v_pk_mul_f32 v[54:55], v[54:55], v[26:27]
    ds_read_b128 v[24:27], v133 offset:7856
    s_waitcnt lgkmcnt(0)
    v_pk_mul_f32 v[56:57], v[56:57], v[20:21]
    v_pk_mul_f32 v[58:59], v[58:59], v[22:23]
    s_waitcnt lgkmcnt(0)
    v_pk_mul_f32 v[60:61], v[60:61], v[24:25]
    v_pk_mul_f32 v[62:63], v[62:63], v[26:27]
    v_pk_mul_f32 v[64:65], v[64:65], v[142:143] op_sel:[0,0] op_sel_hi:[1,0]
    v_fma_f32 v15, v136, v32, v33
    v_pk_mul_f32 v[66:67], v[66:67], v[142:143] op_sel:[0,0] op_sel_hi:[1,0]
    v_fma_f32 v7, v136, v48, v49
    v_pk_mul_f32 v[68:69], v[68:69], v[142:143] op_sel:[0,0] op_sel_hi:[1,0]
    v_fmac_f32_dpp v15, v32, v137 quad_perm:[1,0,3,2] row_mask:0xf bank_mask:0xf
    v_pk_mul_f32 v[70:71], v[70:71], v[142:143] op_sel:[0,0] op_sel_hi:[1,0]
    v_fmac_f32_dpp v7, v48, v137 quad_perm:[1,0,3,2] row_mask:0xf bank_mask:0xf
    v_exp_f32 v20, v64
    v_fma_f32 v14, v136, v15, v34
    v_exp_f32 v21, v65
    v_fma_f32 v0, v136, v7, v50
    v_exp_f32 v22, v66
    v_fmac_f32_dpp v14, v15, v137 quad_perm:[1,0,3,2] row_mask:0xf bank_mask:0xf
    v_exp_f32 v23, v67
    v_fmac_f32_dpp v0, v7, v137 quad_perm:[1,0,3,2] row_mask:0xf bank_mask:0xf
    v_exp_f32 v24, v68
    v_fma_f32 v15, v136, v14, v35
    v_exp_f32 v25, v69
    v_fma_f32 v7, v136, v0, v51
    v_exp_f32 v26, v70
    v_fmac_f32_dpp v15, v14, v137 quad_perm:[1,0,3,2] row_mask:0xf bank_mask:0xf
    v_exp_f32 v27, v71
    v_fmac_f32_dpp v7, v0, v137 quad_perm:[1,0,3,2] row_mask:0xf bank_mask:0xf
    v_pk_mul_f32 v[64:65], v[64:65], v[72:73]
    v_fma_f32 v14, v136, v15, v36
    v_pk_mul_f32 v[66:67], v[66:67], v[74:75]
    v_fma_f32 v0, v136, v7, v52
    v_pk_mul_f32 v[68:69], v[68:69], v[76:77]
    v_fmac_f32_dpp v14, v15, v137 quad_perm:[1,0,3,2] row_mask:0xf bank_mask:0xf
    v_pk_mul_f32 v[70:71], v[70:71], v[78:79]
    v_fmac_f32_dpp v0, v7, v137 quad_perm:[1,0,3,2] row_mask:0xf bank_mask:0xf
    v_pk_fma_f32 v[20:21], v[20:21], v[140:141], v[140:141] op_sel:[0,0,0] op_sel_hi:[1,0,0]
    v_fma_f32 v15, v136, v14, v37
    v_pk_fma_f32 v[22:23], v[22:23], v[140:141], v[140:141] op_sel:[0,0,0] op_sel_hi:[1,0,0]
    v_fma_f32 v7, v136, v0, v53
    v_pk_fma_f32 v[24:25], v[24:25], v[140:141], v[140:141] op_sel:[0,0,0] op_sel_hi:[1,0,0]
    v_fmac_f32_dpp v15, v14, v137 quad_perm:[1,0,3,2] row_mask:0xf bank_mask:0xf
    v_pk_fma_f32 v[26:27], v[26:27], v[140:141], v[140:141] op_sel:[0,0,0] op_sel_hi:[1,0,0]
    v_fmac_f32_dpp v7, v0, v137 quad_perm:[1,0,3,2] row_mask:0xf bank_mask:0xf
    v_rcp_f32 v20, v20
    v_fma_f32 v14, v136, v15, v38
    v_rcp_f32 v21, v21
    v_fma_f32 v0, v136, v7, v54
    v_rcp_f32 v22, v22
    v_fmac_f32_dpp v14, v15, v137 quad_perm:[1,0,3,2] row_mask:0xf bank_mask:0xf
    v_rcp_f32 v23, v23
    v_fmac_f32_dpp v0, v7, v137 quad_perm:[1,0,3,2] row_mask:0xf bank_mask:0xf
    v_rcp_f32 v24, v24
    v_fma_f32 v15, v136, v14, v39
    v_rcp_f32 v25, v25
    v_fma_f32 v7, v136, v0, v55
    v_rcp_f32 v26, v26
    v_fmac_f32_dpp v15, v14, v137 quad_perm:[1,0,3,2] row_mask:0xf bank_mask:0xf
    v_rcp_f32 v27, v27
    v_fmac_f32_dpp v7, v0, v137 quad_perm:[1,0,3,2] row_mask:0xf bank_mask:0xf
    s_nop 0
    v_pk_mul_f32 v[64:65], v[64:65], v[20:21]
    v_fma_f32 v14, v136, v15, v40
    v_pk_mul_f32 v[66:67], v[66:67], v[22:23]
    v_fma_f32 v0, v136, v7, v56
    v_pk_mul_f32 v[68:69], v[68:69], v[24:25]
    v_fmac_f32_dpp v14, v15, v137 quad_perm:[1,0,3,2] row_mask:0xf bank_mask:0xf
    v_pk_mul_f32 v[70:71], v[70:71], v[26:27]
    v_fmac_f32_dpp v0, v7, v137 quad_perm:[1,0,3,2] row_mask:0xf bank_mask:0xf
    v_cvt_pk_bf16_f32 v144, v64, v65
    v_fma_f32 v15, v136, v14, v41
    v_cvt_pk_bf16_f32 v145, v66, v67
    v_fma_f32 v7, v136, v0, v57
    v_cvt_pk_bf16_f32 v146, v68, v69
    v_fmac_f32_dpp v15, v14, v137 quad_perm:[1,0,3,2] row_mask:0xf bank_mask:0xf
    v_cvt_pk_bf16_f32 v147, v70, v71
    v_fmac_f32_dpp v7, v0, v137 quad_perm:[1,0,3,2] row_mask:0xf bank_mask:0xf
    s_add_u32 s77, s71, 0
    buffer_store_dwordx4 v[144:147], v2, s[36:39], s77 offen sc1
    v_pk_mul_f32 v[80:81], v[80:81], v[142:143] op_sel:[0,1] op_sel_hi:[1,1]
    v_fma_f32 v14, v136, v15, v42
    v_pk_mul_f32 v[82:83], v[82:83], v[142:143] op_sel:[0,1] op_sel_hi:[1,1]
    v_fma_f32 v0, v136, v7, v58
    v_pk_mul_f32 v[84:85], v[84:85], v[142:143] op_sel:[0,1] op_sel_hi:[1,1]
    v_fmac_f32_dpp v14, v15, v137 quad_perm:[1,0,3,2] row_mask:0xf bank_mask:0xf
    v_pk_mul_f32 v[86:87], v[86:87], v[142:143] op_sel:[0,1] op_sel_hi:[1,1]
    v_fmac_f32_dpp v0, v7, v137 quad_perm:[1,0,3,2] row_mask:0xf bank_mask:0xf
    v_exp_f32 v20, v80
    v_fma_f32 v15, v136, v14, v43
    v_exp_f32 v21, v81
    v_fma_f32 v7, v136, v0, v59
    v_exp_f32 v22, v82
    v_fmac_f32_dpp v15, v14, v137 quad_perm:[1,0,3,2] row_mask:0xf bank_mask:0xf
    v_exp_f32 v23, v83
    v_fmac_f32_dpp v7, v0, v137 quad_perm:[1,0,3,2] row_mask:0xf bank_mask:0xf
    v_exp_f32 v24, v84
    v_fma_f32 v14, v136, v15, v44
    v_exp_f32 v25, v85
    v_fma_f32 v0, v136, v7, v60
    v_exp_f32 v26, v86
    v_fmac_f32_dpp v14, v15, v137 quad_perm:[1,0,3,2] row_mask:0xf bank_mask:0xf
    v_exp_f32 v27, v87
    v_fmac_f32_dpp v0, v7, v137 quad_perm:[1,0,3,2] row_mask:0xf bank_mask:0xf
    v_pk_mul_f32 v[80:81], v[80:81], v[88:89]
    v_fma_f32 v15, v136, v14, v45
    v_pk_mul_f32 v[82:83], v[82:83], v[90:91]
    v_fma_f32 v7, v136, v0, v61
    v_pk_mul_f32 v[84:85], v[84:85], v[92:93]
    v_fmac_f32_dpp v15, v14, v137 quad_perm:[1,0,3,2] row_mask:0xf bank_mask:0xf
    v_pk_mul_f32 v[86:87], v[86:87], v[94:95]
    v_fmac_f32_dpp v7, v0, v137 quad_perm:[1,0,3,2] row_mask:0xf bank_mask:0xf
    v_pk_fma_f32 v[20:21], v[20:21], v[140:141], v[140:141] op_sel:[0,1,1] op_sel_hi:[1,1,1]
    v_fma_f32 v14, v136, v15, v46
    v_pk_fma_f32 v[22:23], v[22:23], v[140:141], v[140:141] op_sel:[0,1,1] op_sel_hi:[1,1,1]
    v_fma_f32 v0, v136, v7, v62
    v_pk_fma_f32 v[24:25], v[24:25], v[140:141], v[140:141] op_sel:[0,1,1] op_sel_hi:[1,1,1]
    v_fmac_f32_dpp v14, v15, v137 quad_perm:[1,0,3,2] row_mask:0xf bank_mask:0xf
    v_pk_fma_f32 v[26:27], v[26:27], v[140:141], v[140:141] op_sel:[0,1,1] op_sel_hi:[1,1,1]
    v_fmac_f32_dpp v0, v7, v137 quad_perm:[1,0,3,2] row_mask:0xf bank_mask:0xf
    v_rcp_f32 v20, v20
    v_fma_f32 v15, v136, v14, v47
    v_rcp_f32 v21, v21
    v_fma_f32 v7, v136, v0, v63
    v_rcp_f32 v22, v22
    v_fmac_f32_dpp v15, v14, v137 quad_perm:[1,0,3,2] row_mask:0xf bank_mask:0xf
    v_rcp_f32 v23, v23
    v_fmac_f32_dpp v7, v0, v137 quad_perm:[1,0,3,2] row_mask:0xf bank_mask:0xf
    v_rcp_f32 v24, v24
    ds_write_b32 v134, v15 offset:9216
    v_rcp_f32 v25, v25
    ds_write_b32 v134, v7 offset:9224
    v_rcp_f32 v26, v26
    v_rcp_f32 v27, v27
    s_nop 0
    v_pk_mul_f32 v[80:81], v[80:81], v[20:21]
    v_pk_mul_f32 v[82:83], v[82:83], v[22:23]
    v_pk_mul_f32 v[84:85], v[84:85], v[24:25]
    v_pk_mul_f32 v[86:87], v[86:87], v[26:27]
    v_cvt_pk_bf16_f32 v148, v80, v81
    v_cvt_pk_bf16_f32 v149, v82, v83
    v_cvt_pk_bf16_f32 v150, v84, v85
    v_cvt_pk_bf16_f32 v151, v86, v87
    s_add_u32 s77, s71, 172032
    buffer_store_dwordx4 v[148:151], v2, s[36:39], s77 offen sc1
    s_waitcnt lgkmcnt(0)
    s_barrier
    ds_read_b128 a[0:3], v8
    ds_read_b128 a[4:7], v8 offset:4096
    ds_read_b64_tr_b16 a[12:13], v16 offset:0
    ds_read_b64_tr_b16 a[14:15], v16 offset:512
    ds_read_b64_tr_b16 a[16:17], v17 offset:0
    ds_read_b64_tr_b16 a[18:19], v17 offset:512
    ds_read_b128 a[20:23], v9
    ds_read_b128 a[24:27], v9 offset:4096
    ds_read_b64_tr_b16 a[32:33], v16 offset:2048
    ds_read_b64_tr_b16 a[34:35], v16 offset:2560
    ds_read_b64_tr_b16 a[36:37], v17 offset:2048
    ds_read_b64_tr_b16 a[38:39], v17 offset:2560
    v_pk_mul_f32 v[96:97], v[96:97], v[142:143] op_sel:[0,0] op_sel_hi:[1,0]
    v_pk_mul_f32 v[98:99], v[98:99], v[142:143] op_sel:[0,0] op_sel_hi:[1,0]
    v_pk_mul_f32 v[100:101], v[100:101], v[142:143] op_sel:[0,0] op_sel_hi:[1,0]
    v_pk_mul_f32 v[102:103], v[102:103], v[142:143] op_sel:[0,0] op_sel_hi:[1,0]
    v_exp_f32 v20, v96
    v_exp_f32 v21, v97
    v_exp_f32 v22, v98
    v_exp_f32 v23, v99
    v_exp_f32 v24, v100
    v_exp_f32 v25, v101
    v_exp_f32 v26, v102
    v_exp_f32 v27, v103
    v_pk_mul_f32 v[96:97], v[96:97], v[104:105]
    v_pk_mul_f32 v[98:99], v[98:99], v[106:107]
    v_pk_mul_f32 v[100:101], v[100:101], v[108:109]
    v_pk_mul_f32 v[102:103], v[102:103], v[110:111]
    v_pk_fma_f32 v[20:21], v[20:21], v[140:141], v[140:141] op_sel:[0,0,0] op_sel_hi:[1,0,0]
    v_pk_fma_f32 v[22:23], v[22:23], v[140:141], v[140:141] op_sel:[0,0,0] op_sel_hi:[1,0,0]
    v_pk_fma_f32 v[24:25], v[24:25], v[140:141], v[140:141] op_sel:[0,0,0] op_sel_hi:[1,0,0]
    v_pk_fma_f32 v[26:27], v[26:27], v[140:141], v[140:141] op_sel:[0,0,0] op_sel_hi:[1,0,0]
    v_rcp_f32 v20, v20
    v_rcp_f32 v21, v21
    v_rcp_f32 v22, v22
    v_rcp_f32 v23, v23
    v_rcp_f32 v24, v24
    v_rcp_f32 v25, v25
    v_rcp_f32 v26, v26
    v_rcp_f32 v27, v27
    s_nop 0
    v_pk_mul_f32 v[96:97], v[96:97], v[20:21]
    v_pk_mul_f32 v[98:99], v[98:99], v[22:23]
    v_pk_mul_f32 v[100:101], v[100:101], v[24:25]
    v_pk_mul_f32 v[102:103], v[102:103], v[26:27]
    v_cvt_pk_bf16_f32 v152, v96, v97
    v_cvt_pk_bf16_f32 v153, v98, v99
    v_cvt_pk_bf16_f32 v154, v100, v101
    v_cvt_pk_bf16_f32 v155, v102, v103
    s_add_u32 s77, s71, 1024
    buffer_store_dwordx4 v[152:155], v2, s[36:39], s77 offen sc1
    v_pk_mul_f32 v[112:113], v[112:113], v[142:143] op_sel:[0,1] op_sel_hi:[1,1]
    v_pk_mul_f32 v[114:115], v[114:115], v[142:143] op_sel:[0,1] op_sel_hi:[1,1]
    v_pk_mul_f32 v[116:117], v[116:117], v[142:143] op_sel:[0,1] op_sel_hi:[1,1]
    v_pk_mul_f32 v[118:119], v[118:119], v[142:143] op_sel:[0,1] op_sel_hi:[1,1]
    v_exp_f32 v20, v112
    v_exp_f32 v21, v113
    v_exp_f32 v22, v114
    v_exp_f32 v23, v115
    v_exp_f32 v24, v116
    v_exp_f32 v25, v117
    v_exp_f32 v26, v118
    v_exp_f32 v27, v119
    v_pk_mul_f32 v[112:113], v[112:113], v[120:121]
    v_pk_mul_f32 v[114:115], v[114:115], v[122:123]
    v_pk_mul_f32 v[116:117], v[116:117], v[124:125]
    v_pk_mul_f32 v[118:119], v[118:119], v[126:127]
    v_pk_fma_f32 v[20:21], v[20:21], v[140:141], v[140:141] op_sel:[0,1,1] op_sel_hi:[1,1,1]
    v_pk_fma_f32 v[22:23], v[22:23], v[140:141], v[140:141] op_sel:[0,1,1] op_sel_hi:[1,1,1]
    v_pk_fma_f32 v[24:25], v[24:25], v[140:141], v[140:141] op_sel:[0,1,1] op_sel_hi:[1,1,1]
    v_pk_fma_f32 v[26:27], v[26:27], v[140:141], v[140:141] op_sel:[0,1,1] op_sel_hi:[1,1,1]
    v_rcp_f32 v20, v20
    v_rcp_f32 v21, v21
    v_rcp_f32 v22, v22
    v_rcp_f32 v23, v23
    v_rcp_f32 v24, v24
    v_rcp_f32 v25, v25
    v_rcp_f32 v26, v26
    v_rcp_f32 v27, v27
    s_nop 0
    v_pk_mul_f32 v[112:113], v[112:113], v[20:21]
    v_pk_mul_f32 v[114:115], v[114:115], v[22:23]
    v_pk_mul_f32 v[116:117], v[116:117], v[24:25]
    v_pk_mul_f32 v[118:119], v[118:119], v[26:27]
    v_cvt_pk_bf16_f32 v156, v112, v113
    v_cvt_pk_bf16_f32 v157, v114, v115
    v_cvt_pk_bf16_f32 v158, v116, v117
    v_cvt_pk_bf16_f32 v159, v118, v119
    s_add_u32 s77, s71, 173056
    buffer_store_dwordx4 v[156:159], v2, s[36:39], s77 offen sc1
    s_waitcnt lgkmcnt(6)
    v_mfma_f32_32x32x16_bf16 v[64:79], a[12:15], a[0:3], 0
    ds_read_b128 v[172:175], v10
    ds_read_b128 v[176:179], v10 offset:4096
    v_mfma_f32_32x32x16_bf16 v[80:95], a[12:15], a[4:7], 0
    ds_read_b64_tr_b16 v[184:185], v16 offset:4096
    ds_read_b64_tr_b16 v[186:187], v16 offset:4608
    v_mfma_f32_32x32x16_bf16 v[96:111], a[16:19], a[0:3], 0
    ds_read_b64_tr_b16 v[188:189], v17 offset:4096
    ds_read_b64_tr_b16 v[190:191], v17 offset:4608
    v_mfma_f32_32x32x16_bf16 v[112:127], a[16:19], a[4:7], 0
    s_waitcnt lgkmcnt(6)
    v_mfma_f32_32x32x16_bf16 v[64:79], a[32:35], a[20:23], v[64:79]
    ds_read_b128 a[0:3], v11
    ds_read_b128 a[4:7], v11 offset:4096
    v_mfma_f32_32x32x16_bf16 v[80:95], a[32:35], a[24:27], v[80:95]
    ds_read_b64_tr_b16 a[12:13], v16 offset:6144
    ds_read_b64_tr_b16 a[14:15], v16 offset:6656
    v_mfma_f32_32x32x16_bf16 v[96:111], a[36:39], a[20:23], v[96:111]
    ds_read_b64_tr_b16 a[16:17], v17 offset:6144
    ds_read_b64_tr_b16 a[18:19], v17 offset:6656
    v_mfma_f32_32x32x16_bf16 v[112:127], a[36:39], a[24:27], v[112:127]
    s_waitcnt lgkmcnt(6)
    v_mfma_f32_32x32x16_bf16 v[64:79], v[184:187], v[172:175], v[64:79]
    v_mfma_f32_32x32x16_bf16 v[80:95], v[184:187], v[176:179], v[80:95]
    v_mfma_f32_32x32x16_bf16 v[96:111], v[188:191], v[172:175], v[96:111]
    s_waitcnt lgkmcnt(0)
    s_barrier
    v_add_u32 v8, 4294868992, v8
    v_add_u32 v9, 4294868992, v9
    v_add_u32 v10, 4294868992, v10
    v_add_u32 v11, 4294868992, v11
    v_add_u32 v16, 4294868992, v16
    v_add_u32 v17, 4294868992, v17
    ds_read_b128 a[20:23], v8
    ds_read_b128 a[24:27], v8 offset:4096
    ds_read_b64_tr_b16 a[32:33], v16 offset:0
    v_mfma_f32_32x32x16_bf16 v[112:127], v[188:191], v[176:179], v[112:127]
    ds_read_b64_tr_b16 a[34:35], v16 offset:512
    ds_read_b64_tr_b16 a[36:37], v17 offset:0
    ds_read_b64_tr_b16 a[38:39], v17 offset:512
    v_mfma_f32_32x32x16_bf16 v[64:79], a[12:15], a[0:3], v[64:79]
    ds_read_b128 v[172:175], v9
    ds_read_b128 v[176:179], v9 offset:4096
    v_mfma_f32_32x32x16_bf16 v[80:95], a[12:15], a[4:7], v[80:95]
    ds_read_b64_tr_b16 v[184:185], v16 offset:2048
    ds_read_b64_tr_b16 v[186:187], v16 offset:2560
    v_mfma_f32_32x32x16_bf16 v[96:111], a[16:19], a[0:3], v[96:111]
    ds_read_b64_tr_b16 v[188:189], v17 offset:2048
    ds_read_b64_tr_b16 v[190:191], v17 offset:2560
    v_mfma_f32_32x32x16_bf16 v[112:127], a[16:19], a[4:7], v[112:127]
    s_waitcnt lgkmcnt(6)
    v_mfma_f32_32x32x16_bf16 v[64:79], a[32:35], a[20:23], v[64:79]
    ds_read_b128 a[0:3], v10
    ds_read_b128 a[4:7], v10 offset:4096
    v_mfma_f32_32x32x16_bf16 v[80:95], a[32:35], a[24:27], v[80:95]
    ds_read_b64_tr_b16 a[12:13], v16 offset:4096
    ds_read_b64_tr_b16 a[14:15], v16 offset:4608
    v_mfma_f32_32x32x16_bf16 v[96:111], a[36:39], a[20:23], v[96:111]
    ds_read_b64_tr_b16 a[16:17], v17 offset:4096
    ds_read_b64_tr_b16 a[18:19], v17 offset:4608
    v_mfma_f32_32x32x16_bf16 v[112:127], a[36:39], a[24:27], v[112:127]
    s_waitcnt lgkmcnt(6)
    v_mfma_f32_32x32x16_bf16 v[64:79], v[184:187], v[172:175], v[64:79]
    ds_read_b128 a[20:23], v11
    ds_read_b128 a[24:27], v11 offset:4096
    v_mfma_f32_32x32x16_bf16 v[80:95], v[184:187], v[176:179], v[80:95]
    ds_read_b64_tr_b16 a[32:33], v16 offset:6144
    ds_read_b64_tr_b16 a[34:35], v16 offset:6656
    v_mfma_f32_32x32x16_bf16 v[96:111], v[188:191], v[172:175], v[96:111]
    ds_read_b64_tr_b16 a[36:37], v17 offset:6144
    ds_read_b64_tr_b16 a[38:39], v17 offset:6656
    v_mfma_f32_32x32x16_bf16 v[112:127], v[188:191], v[176:179], v[112:127]
    s_waitcnt lgkmcnt(6)
    v_mfma_f32_32x32x16_bf16 v[64:79], a[12:15], a[0:3], v[64:79]
    v_mfma_f32_32x32x16_bf16 v[80:95], a[12:15], a[4:7], v[80:95]
    v_mfma_f32_32x32x16_bf16 v[96:111], a[16:19], a[0:3], v[96:111]
    s_waitcnt lgkmcnt(0)
    s_barrier
    v_add_u32 v8, 32768, v8
    v_add_u32 v9, 32768, v9
    v_add_u32 v10, 32768, v10
    v_add_u32 v11, 32768, v11
    v_add_u32 v16, 32768, v16
    v_add_u32 v17, 32768, v17
    ds_read_b128 v[172:175], v8
    ds_read_b128 v[176:179], v8 offset:4096
    ds_read_b64_tr_b16 v[184:185], v16 offset:0
    v_mfma_f32_32x32x16_bf16 v[112:127], a[16:19], a[4:7], v[112:127]
    ds_read_b64_tr_b16 v[186:187], v16 offset:512
    ds_read_b64_tr_b16 v[188:189], v17 offset:0
    ds_read_b64_tr_b16 v[190:191], v17 offset:512
    v_mfma_f32_32x32x16_bf16 v[64:79], a[32:35], a[20:23], v[64:79]
    ds_read_b128 a[0:3], v9
    ds_read_b128 a[4:7], v9 offset:4096
    v_mfma_f32_32x32x16_bf16 v[80:95], a[32:35], a[24:27], v[80:95]
    ds_read_b64_tr_b16 a[12:13], v16 offset:2048
    ds_read_b64_tr_b16 a[14:15], v16 offset:2560
    v_mfma_f32_32x32x16_bf16 v[96:111], a[36:39], a[20:23], v[96:111]
    ds_read_b64_tr_b16 a[16:17], v17 offset:2048
    ds_read_b64_tr_b16 a[18:19], v17 offset:2560
    v_mfma_f32_32x32x16_bf16 v[112:127], a[36:39], a[24:27], v[112:127]
    s_waitcnt lgkmcnt(6)
    v_mfma_f32_32x32x16_bf16 v[64:79], v[184:187], v[172:175], v[64:79]
    ds_read_b128 a[20:23], v10
    ds_read_b128 a[24:27], v10 offset:4096
    v_mfma_f32_32x32x16_bf16 v[80:95], v[184:187], v[176:179], v[80:95]
    ds_read_b64_tr_b16 a[32:33], v16 offset:4096
    ds_read_b64_tr_b16 a[34:35], v16 offset:4608
    v_mfma_f32_32x32x16_bf16 v[96:111], v[188:191], v[172:175], v[96:111]
    ds_read_b64_tr_b16 a[36:37], v17 offset:4096
    ds_read_b64_tr_b16 a[38:39], v17 offset:4608
    v_mfma_f32_32x32x16_bf16 v[112:127], v[188:191], v[176:179], v[112:127]
    s_waitcnt lgkmcnt(6)
    v_mfma_f32_32x32x16_bf16 v[64:79], a[12:15], a[0:3], v[64:79]
    ds_read_b128 v[172:175], v11
    ds_read_b128 v[176:179], v11 offset:4096
    v_mfma_f32_32x32x16_bf16 v[80:95], a[12:15], a[4:7], v[80:95]
    ds_read_b64_tr_b16 v[184:185], v16 offset:6144
    ds_read_b64_tr_b16 v[186:187], v16 offset:6656
    v_mfma_f32_32x32x16_bf16 v[96:111], a[16:19], a[0:3], v[96:111]
    ds_read_b64_tr_b16 v[188:189], v17 offset:6144
    ds_read_b64_tr_b16 v[190:191], v17 offset:6656
    v_mfma_f32_32x32x16_bf16 v[112:127], a[16:19], a[4:7], v[112:127]
    s_waitcnt lgkmcnt(6)
    v_mfma_f32_32x32x16_bf16 v[64:79], a[32:35], a[20:23], v[64:79]
    v_mfma_f32_32x32x16_bf16 v[80:95], a[32:35], a[24:27], v[80:95]
    v_mfma_f32_32x32x16_bf16 v[96:111], a[36:39], a[20:23], v[96:111]
    s_waitcnt lgkmcnt(0)
    s_waitcnt vmcnt(0)
    s_barrier
    v_add_u32 v8, 32768, v8
    v_add_u32 v9, 32768, v9
    v_add_u32 v10, 32768, v10
    v_add_u32 v11, 32768, v11
    v_add_u32 v16, 32768, v16
    v_add_u32 v17, 32768, v17
    ds_read_b128 a[0:3], v8
    ds_read_b128 a[4:7], v8 offset:4096
    ds_read_b64_tr_b16 a[12:13], v16 offset:0
    v_mfma_f32_32x32x16_bf16 v[112:127], a[36:39], a[24:27], v[112:127]
    ds_read_b64_tr_b16 a[14:15], v16 offset:512
    ds_read_b64_tr_b16 a[16:17], v17 offset:0
    ds_read_b64_tr_b16 a[18:19], v17 offset:512
    v_mfma_f32_32x32x16_bf16 v[64:79], v[184:187], v[172:175], v[64:79]
    ds_read_b128 a[20:23], v9
    ds_read_b128 a[24:27], v9 offset:4096
    v_mfma_f32_32x32x16_bf16 v[80:95], v[184:187], v[176:179], v[80:95]
    ds_read_b64_tr_b16 a[32:33], v16 offset:2048
    ds_read_b64_tr_b16 a[34:35], v16 offset:2560
    v_mfma_f32_32x32x16_bf16 v[96:111], v[188:191], v[172:175], v[96:111]
    ds_read_b64_tr_b16 a[36:37], v17 offset:2048
    ds_read_b64_tr_b16 a[38:39], v17 offset:2560
    v_mfma_f32_32x32x16_bf16 v[112:127], v[188:191], v[176:179], v[112:127]
    s_waitcnt lgkmcnt(6)
    v_mfma_f32_32x32x16_bf16 v[64:79], a[12:15], a[0:3], v[64:79]
    ds_read_b128 v[172:175], v10
    ds_read_b128 v[176:179], v10 offset:4096
    v_mfma_f32_32x32x16_bf16 v[80:95], a[12:15], a[4:7], v[80:95]
    ds_read_b64_tr_b16 v[184:185], v16 offset:4096
    ds_read_b64_tr_b16 v[186:187], v16 offset:4608
    v_mfma_f32_32x32x16_bf16 v[96:111], a[16:19], a[0:3], v[96:111]
    ds_read_b64_tr_b16 v[188:189], v17 offset:4096
    ds_read_b64_tr_b16 v[190:191], v17 offset:4608
    v_mfma_f32_32x32x16_bf16 v[112:127], a[16:19], a[4:7], v[112:127]
    s_waitcnt lgkmcnt(6)
    v_mfma_f32_32x32x16_bf16 v[64:79], a[32:35], a[20:23], v[64:79]
    ds_read_b128 a[0:3], v11
    ds_read_b128 a[4:7], v11 offset:4096
    v_mfma_f32_32x32x16_bf16 v[80:95], a[32:35], a[24:27], v[80:95]
    ds_read_b64_tr_b16 a[12:13], v16 offset:6144
    ds_read_b64_tr_b16 a[14:15], v16 offset:6656
    v_mfma_f32_32x32x16_bf16 v[96:111], a[36:39], a[20:23], v[96:111]
    ds_read_b64_tr_b16 a[16:17], v17 offset:6144
    ds_read_b64_tr_b16 a[18:19], v17 offset:6656
    v_mfma_f32_32x32x16_bf16 v[112:127], a[36:39], a[24:27], v[112:127]
    s_waitcnt lgkmcnt(6)
    v_mfma_f32_32x32x16_bf16 v[64:79], v[184:187], v[172:175], v[64:79]
    v_mfma_f32_32x32x16_bf16 v[80:95], v[184:187], v[176:179], v[80:95]
    v_mfma_f32_32x32x16_bf16 v[96:111], v[188:191], v[172:175], v[96:111]
    s_waitcnt lgkmcnt(0)
    s_barrier
    v_add_u32 v8, 32768, v8
    v_add_u32 v9, 32768, v9
    v_add_u32 v10, 32768, v10
    v_add_u32 v11, 32768, v11
    v_add_u32 v16, 32768, v16
    v_add_u32 v17, 32768, v17
    ds_read_b128 a[20:23], v8
    ds_read_b128 a[24:27], v8 offset:4096
    ds_read_b64_tr_b16 a[32:33], v16 offset:0
    v_mfma_f32_32x32x16_bf16 v[112:127], v[188:191], v[176:179], v[112:127]
    ds_read_b64_tr_b16 a[34:35], v16 offset:512
    ds_read_b64_tr_b16 a[36:37], v17 offset:0
    ds_read_b64_tr_b16 a[38:39], v17 offset:512
    v_mfma_f32_32x32x16_bf16 v[64:79], a[12:15], a[0:3], v[64:79]
    ds_read_b128 v[172:175], v9
    ds_read_b128 v[176:179], v9 offset:4096
    v_mfma_f32_32x32x16_bf16 v[80:95], a[12:15], a[4:7], v[80:95]
    ds_read_b64_tr_b16 v[184:185], v16 offset:2048
    ds_read_b64_tr_b16 v[186:187], v16 offset:2560
    v_mfma_f32_32x32x16_bf16 v[96:111], a[16:19], a[0:3], v[96:111]
    ds_read_b64_tr_b16 v[188:189], v17 offset:2048
    ds_read_b64_tr_b16 v[190:191], v17 offset:2560
    v_mfma_f32_32x32x16_bf16 v[112:127], a[16:19], a[4:7], v[112:127]
    s_waitcnt lgkmcnt(6)
    v_mfma_f32_32x32x16_bf16 v[64:79], a[32:35], a[20:23], v[64:79]
    ds_read_b128 a[0:3], v10
    ds_read_b128 a[4:7], v10 offset:4096
    v_mfma_f32_32x32x16_bf16 v[80:95], a[32:35], a[24:27], v[80:95]
    ds_read_b64_tr_b16 a[12:13], v16 offset:4096
    ds_read_b64_tr_b16 a[14:15], v16 offset:4608
    v_mfma_f32_32x32x16_bf16 v[96:111], a[36:39], a[20:23], v[96:111]
    ds_read_b64_tr_b16 a[16:17], v17 offset:4096
    ds_read_b64_tr_b16 a[18:19], v17 offset:4608
    v_mfma_f32_32x32x16_bf16 v[112:127], a[36:39], a[24:27], v[112:127]
    s_waitcnt lgkmcnt(6)
    v_mfma_f32_32x32x16_bf16 v[64:79], v[184:187], v[172:175], v[64:79]
    ds_read_b128 a[20:23], v11
    ds_read_b128 a[24:27], v11 offset:4096
    v_mfma_f32_32x32x16_bf16 v[80:95], v[184:187], v[176:179], v[80:95]
    ds_read_b64_tr_b16 a[32:33], v16 offset:6144
    ds_read_b64_tr_b16 a[34:35], v16 offset:6656
    v_mfma_f32_32x32x16_bf16 v[96:111], v[188:191], v[172:175], v[96:111]
    ds_read_b64_tr_b16 a[36:37], v17 offset:6144
    ds_read_b64_tr_b16 a[38:39], v17 offset:6656
    v_mfma_f32_32x32x16_bf16 v[112:127], v[188:191], v[176:179], v[112:127]
    s_waitcnt lgkmcnt(6)
    v_mfma_f32_32x32x16_bf16 v[64:79], a[12:15], a[0:3], v[64:79]
    v_mfma_f32_32x32x16_bf16 v[80:95], a[12:15], a[4:7], v[80:95]
    v_mfma_f32_32x32x16_bf16 v[96:111], a[16:19], a[0:3], v[96:111]
    s_waitcnt lgkmcnt(0)
    s_barrier
    v_add_u32 v8, 4294868992, v8
    v_add_u32 v9, 4294868992, v9
    v_add_u32 v10, 4294868992, v10
    v_add_u32 v11, 4294868992, v11
    v_add_u32 v16, 4294868992, v16
    v_add_u32 v17, 4294868992, v17
    ds_read_b128 v[172:175], v8
    ds_read_b128 v[176:179], v8 offset:4096
    ds_read_b64_tr_b16 v[184:185], v16 offset:0
    v_mfma_f32_32x32x16_bf16 v[112:127], a[16:19], a[4:7], v[112:127]
    ds_read_b64_tr_b16 v[186:187], v16 offset:512
    ds_read_b64_tr_b16 v[188:189], v17 offset:0
    ds_read_b64_tr_b16 v[190:191], v17 offset:512
    v_mfma_f32_32x32x16_bf16 v[64:79], a[32:35], a[20:23], v[64:79]
    ds_read_b128 a[0:3], v9
    ds_read_b128 a[4:7], v9 offset:4096
    v_mfma_f32_32x32x16_bf16 v[80:95], a[32:35], a[24:27], v[80:95]
    ds_read_b64_tr_b16 a[12:13], v16 offset:2048
    ds_read_b64_tr_b16 a[14:15], v16 offset:2560
    v_mfma_f32_32x32x16_bf16 v[96:111], a[36:39], a[20:23], v[96:111]
    ds_read_b64_tr_b16 a[16:17], v17 offset:2048
    ds_read_b64_tr_b16 a[18:19], v17 offset:2560
    v_mfma_f32_32x32x16_bf16 v[112:127], a[36:39], a[24:27], v[112:127]
    s_waitcnt lgkmcnt(6)
    v_mfma_f32_32x32x16_bf16 v[64:79], v[184:187], v[172:175], v[64:79]
    ds_read_b128 a[20:23], v10
    ds_read_b128 a[24:27], v10 offset:4096
    v_mfma_f32_32x32x16_bf16 v[80:95], v[184:187], v[176:179], v[80:95]
    ds_read_b64_tr_b16 a[32:33], v16 offset:4096
    ds_read_b64_tr_b16 a[34:35], v16 offset:4608
    v_mfma_f32_32x32x16_bf16 v[96:111], v[188:191], v[172:175], v[96:111]
    ds_read_b64_tr_b16 a[36:37], v17 offset:4096
    ds_read_b64_tr_b16 a[38:39], v17 offset:4608
    v_mfma_f32_32x32x16_bf16 v[112:127], v[188:191], v[176:179], v[112:127]
    s_waitcnt lgkmcnt(6)
    v_mfma_f32_32x32x16_bf16 v[64:79], a[12:15], a[0:3], v[64:79]
    ds_read_b128 v[172:175], v11
    ds_read_b128 v[176:179], v11 offset:4096
    v_mfma_f32_32x32x16_bf16 v[80:95], a[12:15], a[4:7], v[80:95]
    ds_read_b64_tr_b16 v[184:185], v16 offset:6144
    ds_read_b64_tr_b16 v[186:187], v16 offset:6656
    v_mfma_f32_32x32x16_bf16 v[96:111], a[16:19], a[0:3], v[96:111]
    ds_read_b64_tr_b16 v[188:189], v17 offset:6144
    ds_read_b64_tr_b16 v[190:191], v17 offset:6656
    v_mfma_f32_32x32x16_bf16 v[112:127], a[16:19], a[4:7], v[112:127]
    s_waitcnt lgkmcnt(6)
    v_mfma_f32_32x32x16_bf16 v[64:79], a[32:35], a[20:23], v[64:79]
    v_mfma_f32_32x32x16_bf16 v[80:95], a[32:35], a[24:27], v[80:95]
    v_mfma_f32_32x32x16_bf16 v[96:111], a[36:39], a[20:23], v[96:111]
    s_waitcnt lgkmcnt(0)
    s_barrier
    v_add_u32 v8, 32768, v8
    v_add_u32 v9, 32768, v9
    v_add_u32 v10, 32768, v10
    v_add_u32 v11, 32768, v11
    v_add_u32 v16, 32768, v16
    v_add_u32 v17, 32768, v17
    ds_read_b128 a[0:3], v8
    ds_read_b128 a[4:7], v8 offset:4096
    ds_read_b64_tr_b16 a[12:13], v16 offset:0
    v_mfma_f32_32x32x16_bf16 v[112:127], a[36:39], a[24:27], v[112:127]
    ds_read_b64_tr_b16 a[14:15], v16 offset:512
    ds_read_b64_tr_b16 a[16:17], v17 offset:0
    ds_read_b64_tr_b16 a[18:19], v17 offset:512
    v_mfma_f32_32x32x16_bf16 v[64:79], v[184:187], v[172:175], v[64:79]
    ds_read_b128 a[20:23], v9
    ds_read_b128 a[24:27], v9 offset:4096
    v_mfma_f32_32x32x16_bf16 v[80:95], v[184:187], v[176:179], v[80:95]
    ds_read_b64_tr_b16 a[32:33], v16 offset:2048
    ds_read_b64_tr_b16 a[34:35], v16 offset:2560
    v_mfma_f32_32x32x16_bf16 v[96:111], v[188:191], v[172:175], v[96:111]
    ds_read_b64_tr_b16 a[36:37], v17 offset:2048
    ds_read_b64_tr_b16 a[38:39], v17 offset:2560
    v_mfma_f32_32x32x16_bf16 v[112:127], v[188:191], v[176:179], v[112:127]
    s_waitcnt lgkmcnt(6)
    v_mfma_f32_32x32x16_bf16 v[64:79], a[12:15], a[0:3], v[64:79]
    ds_read_b128 v[172:175], v10
    ds_read_b128 v[176:179], v10 offset:4096
    v_mfma_f32_32x32x16_bf16 v[80:95], a[12:15], a[4:7], v[80:95]
    ds_read_b64_tr_b16 v[184:185], v16 offset:4096
    ds_read_b64_tr_b16 v[186:187], v16 offset:4608
    v_mfma_f32_32x32x16_bf16 v[96:111], a[16:19], a[0:3], v[96:111]
    ds_read_b64_tr_b16 v[188:189], v17 offset:4096
    ds_read_b64_tr_b16 v[190:191], v17 offset:4608
    v_mfma_f32_32x32x16_bf16 v[112:127], a[16:19], a[4:7], v[112:127]
    s_waitcnt lgkmcnt(6)
    v_mfma_f32_32x32x16_bf16 v[64:79], a[32:35], a[20:23], v[64:79]
    ds_read_b128 a[0:3], v11
    ds_read_b128 a[4:7], v11 offset:4096
    v_mfma_f32_32x32x16_bf16 v[80:95], a[32:35], a[24:27], v[80:95]
    ds_read_b64_tr_b16 a[12:13], v16 offset:6144
    ds_read_b64_tr_b16 a[14:15], v16 offset:6656
    v_mfma_f32_32x32x16_bf16 v[96:111], a[36:39], a[20:23], v[96:111]
    ds_read_b64_tr_b16 a[16:17], v17 offset:6144
    ds_read_b64_tr_b16 a[18:19], v17 offset:6656
    v_mfma_f32_32x32x16_bf16 v[112:127], a[36:39], a[24:27], v[112:127]
    s_waitcnt lgkmcnt(6)
    v_mfma_f32_32x32x16_bf16 v[64:79], v[184:187], v[172:175], v[64:79]
    v_mfma_f32_32x32x16_bf16 v[80:95], v[184:187], v[176:179], v[80:95]
    v_mfma_f32_32x32x16_bf16 v[96:111], v[188:191], v[172:175], v[96:111]
    s_waitcnt lgkmcnt(0)
    s_barrier
    ds_read_b64 a[52:53], v129 offset:4096
    ds_read_b64 a[56:57], v129 offset:4608
    v_mfma_f32_32x32x16_bf16 v[112:127], v[188:191], v[176:179], v[112:127]
    v_mfma_f32_32x32x16_bf16 v[64:79], a[12:15], a[0:3], v[64:79]
    v_mfma_f32_32x32x16_bf16 v[80:95], a[12:15], a[4:7], v[80:95]
    v_mfma_f32_32x32x16_bf16 v[96:111], a[16:19], a[0:3], v[96:111]
    v_mfma_f32_32x32x16_bf16 v[112:127], a[16:19], a[4:7], v[112:127]
    s_waitcnt lgkmcnt(0)
    v_mfma_f32_32x32x16_bf16 v[64:79], a[52:55], a[40:43], v[64:79]
    v_mfma_f32_32x32x16_bf16 v[80:95], a[52:55], a[44:47], v[80:95]
    v_mfma_f32_32x32x16_bf16 v[96:111], a[56:59], a[40:43], v[96:111]
    v_mfma_f32_32x32x16_bf16 v[112:127], a[56:59], a[44:47], v[112:127]
    s_nop 15
    v_pk_mul_f32 v[64:65], v[64:65], v[142:143] op_sel:[0,0] op_sel_hi:[1,0]
    v_pk_mul_f32 v[66:67], v[66:67], v[142:143] op_sel:[0,0] op_sel_hi:[1,0]
    v_pk_mul_f32 v[68:69], v[68:69], v[142:143] op_sel:[0,0] op_sel_hi:[1,0]
    v_pk_mul_f32 v[70:71], v[70:71], v[142:143] op_sel:[0,0] op_sel_hi:[1,0]
    v_exp_f32 v20, v64
    v_exp_f32 v21, v65
    v_exp_f32 v22, v66
    v_exp_f32 v23, v67
    v_exp_f32 v24, v68
    v_exp_f32 v25, v69
    v_exp_f32 v26, v70
    v_exp_f32 v27, v71
    v_pk_mul_f32 v[64:65], v[64:65], v[72:73]
    v_pk_mul_f32 v[66:67], v[66:67], v[74:75]
    v_pk_mul_f32 v[68:69], v[68:69], v[76:77]
    v_pk_mul_f32 v[70:71], v[70:71], v[78:79]
    v_pk_fma_f32 v[20:21], v[20:21], v[140:141], v[140:141] op_sel:[0,0,0] op_sel_hi:[1,0,0]
    v_pk_fma_f32 v[22:23], v[22:23], v[140:141], v[140:141] op_sel:[0,0,0] op_sel_hi:[1,0,0]
    v_pk_fma_f32 v[24:25], v[24:25], v[140:141], v[140:141] op_sel:[0,0,0] op_sel_hi:[1,0,0]
    v_pk_fma_f32 v[26:27], v[26:27], v[140:141], v[140:141] op_sel:[0,0,0] op_sel_hi:[1,0,0]
    v_rcp_f32 v20, v20
    v_rcp_f32 v21, v21
    v_rcp_f32 v22, v22
    v_rcp_f32 v23, v23
    v_rcp_f32 v24, v24
    v_rcp_f32 v25, v25
    v_rcp_f32 v26, v26
    v_rcp_f32 v27, v27
    s_nop 0
    v_pk_mul_f32 v[64:65], v[64:65], v[20:21]
    v_pk_mul_f32 v[66:67], v[66:67], v[22:23]
    v_pk_mul_f32 v[68:69], v[68:69], v[24:25]
    v_pk_mul_f32 v[70:71], v[70:71], v[26:27]
    v_cvt_pk_bf16_f32 v160, v64, v65
    v_cvt_pk_bf16_f32 v161, v66, v67
    v_cvt_pk_bf16_f32 v162, v68, v69
    v_cvt_pk_bf16_f32 v163, v70, v71
    s_add_u32 s77, s71, 4096
    buffer_store_dwordx4 v[160:163], v2, s[36:39], s77 offen sc1
    v_pk_mul_f32 v[80:81], v[80:81], v[142:143] op_sel:[0,1] op_sel_hi:[1,1]
    v_pk_mul_f32 v[82:83], v[82:83], v[142:143] op_sel:[0,1] op_sel_hi:[1,1]
    v_pk_mul_f32 v[84:85], v[84:85], v[142:143] op_sel:[0,1] op_sel_hi:[1,1]
    v_pk_mul_f32 v[86:87], v[86:87], v[142:143] op_sel:[0,1] op_sel_hi:[1,1]
    v_exp_f32 v20, v80
    v_exp_f32 v21, v81
    v_exp_f32 v22, v82
    v_exp_f32 v23, v83
    v_exp_f32 v24, v84
    v_exp_f32 v25, v85
    v_exp_f32 v26, v86
    v_exp_f32 v27, v87
    v_pk_mul_f32 v[80:81], v[80:81], v[88:89]
    v_pk_mul_f32 v[82:83], v[82:83], v[90:91]
    v_pk_mul_f32 v[84:85], v[84:85], v[92:93]
    v_pk_mul_f32 v[86:87], v[86:87], v[94:95]
    v_pk_fma_f32 v[20:21], v[20:21], v[140:141], v[140:141] op_sel:[0,1,1] op_sel_hi:[1,1,1]
    v_pk_fma_f32 v[22:23], v[22:23], v[140:141], v[140:141] op_sel:[0,1,1] op_sel_hi:[1,1,1]
    v_pk_fma_f32 v[24:25], v[24:25], v[140:141], v[140:141] op_sel:[0,1,1] op_sel_hi:[1,1,1]
    v_pk_fma_f32 v[26:27], v[26:27], v[140:141], v[140:141] op_sel:[0,1,1] op_sel_hi:[1,1,1]
    v_rcp_f32 v20, v20
    v_rcp_f32 v21, v21
    v_rcp_f32 v22, v22
    v_rcp_f32 v23, v23
    v_rcp_f32 v24, v24
    v_rcp_f32 v25, v25
    v_rcp_f32 v26, v26
    v_rcp_f32 v27, v27
    s_nop 0
    v_pk_mul_f32 v[80:81], v[80:81], v[20:21]
    v_pk_mul_f32 v[82:83], v[82:83], v[22:23]
    v_pk_mul_f32 v[84:85], v[84:85], v[24:25]
    v_pk_mul_f32 v[86:87], v[86:87], v[26:27]
    v_cvt_pk_bf16_f32 v164, v80, v81
    v_cvt_pk_bf16_f32 v165, v82, v83
    v_cvt_pk_bf16_f32 v166, v84, v85
    v_cvt_pk_bf16_f32 v167, v86, v87
    s_add_u32 s77, s71, 176128
    buffer_store_dwordx4 v[164:167], v2, s[36:39], s77 offen sc1
    v_pk_mul_f32 v[96:97], v[96:97], v[142:143] op_sel:[0,0] op_sel_hi:[1,0]
    v_pk_mul_f32 v[98:99], v[98:99], v[142:143] op_sel:[0,0] op_sel_hi:[1,0]
    v_pk_mul_f32 v[100:101], v[100:101], v[142:143] op_sel:[0,0] op_sel_hi:[1,0]
    v_pk_mul_f32 v[102:103], v[102:103], v[142:143] op_sel:[0,0] op_sel_hi:[1,0]
    v_exp_f32 v20, v96
    v_exp_f32 v21, v97
    v_exp_f32 v22, v98
    v_exp_f32 v23, v99
    v_exp_f32 v24, v100
    v_exp_f32 v25, v101
    v_exp_f32 v26, v102
    v_exp_f32 v27, v103
    v_pk_mul_f32 v[96:97], v[96:97], v[104:105]
    v_pk_mul_f32 v[98:99], v[98:99], v[106:107]
    v_pk_mul_f32 v[100:101], v[100:101], v[108:109]
    v_pk_mul_f32 v[102:103], v[102:103], v[110:111]
    v_pk_fma_f32 v[20:21], v[20:21], v[140:141], v[140:141] op_sel:[0,0,0] op_sel_hi:[1,0,0]
    v_pk_fma_f32 v[22:23], v[22:23], v[140:141], v[140:141] op_sel:[0,0,0] op_sel_hi:[1,0,0]
    v_pk_fma_f32 v[24:25], v[24:25], v[140:141], v[140:141] op_sel:[0,0,0] op_sel_hi:[1,0,0]
    v_pk_fma_f32 v[26:27], v[26:27], v[140:141], v[140:141] op_sel:[0,0,0] op_sel_hi:[1,0,0]
    v_rcp_f32 v20, v20
    v_rcp_f32 v21, v21
    v_rcp_f32 v22, v22
    v_rcp_f32 v23, v23
    v_rcp_f32 v24, v24
    v_rcp_f32 v25, v25
    v_rcp_f32 v26, v26
    v_rcp_f32 v27, v27
    s_nop 0
    v_pk_mul_f32 v[96:97], v[96:97], v[20:21]
    v_pk_mul_f32 v[98:99], v[98:99], v[22:23]
    v_pk_mul_f32 v[100:101], v[100:101], v[24:25]
    v_pk_mul_f32 v[102:103], v[102:103], v[26:27]
    v_cvt_pk_bf16_f32 v168, v96, v97
    v_cvt_pk_bf16_f32 v169, v98, v99
    v_cvt_pk_bf16_f32 v170, v100, v101
    v_cvt_pk_bf16_f32 v171, v102, v103
    s_add_u32 s77, s71, 5120
    buffer_store_dwordx4 v[168:171], v2, s[36:39], s77 offen sc1
    v_pk_mul_f32 v[112:113], v[112:113], v[142:143] op_sel:[0,1] op_sel_hi:[1,1]
    v_pk_mul_f32 v[114:115], v[114:115], v[142:143] op_sel:[0,1] op_sel_hi:[1,1]
    v_pk_mul_f32 v[116:117], v[116:117], v[142:143] op_sel:[0,1] op_sel_hi:[1,1]
    v_pk_mul_f32 v[118:119], v[118:119], v[142:143] op_sel:[0,1] op_sel_hi:[1,1]
    v_exp_f32 v20, v112
    v_exp_f32 v21, v113
    v_exp_f32 v22, v114
    v_exp_f32 v23, v115
    v_exp_f32 v24, v116
    v_exp_f32 v25, v117
    v_exp_f32 v26, v118
    v_exp_f32 v27, v119
    v_pk_mul_f32 v[112:113], v[112:113], v[120:121]
    v_pk_mul_f32 v[114:115], v[114:115], v[122:123]
    v_pk_mul_f32 v[116:117], v[116:117], v[124:125]
    v_pk_mul_f32 v[118:119], v[118:119], v[126:127]
    v_pk_fma_f32 v[20:21], v[20:21], v[140:141], v[140:141] op_sel:[0,1,1] op_sel_hi:[1,1,1]
    v_pk_fma_f32 v[22:23], v[22:23], v[140:141], v[140:141] op_sel:[0,1,1] op_sel_hi:[1,1,1]
    v_pk_fma_f32 v[24:25], v[24:25], v[140:141], v[140:141] op_sel:[0,1,1] op_sel_hi:[1,1,1]
    v_pk_fma_f32 v[26:27], v[26:27], v[140:141], v[140:141] op_sel:[0,1,1] op_sel_hi:[1,1,1]
    v_rcp_f32 v20, v20
    v_rcp_f32 v21, v21
    v_rcp_f32 v22, v22
    v_rcp_f32 v23, v23
    v_rcp_f32 v24, v24
    v_rcp_f32 v25, v25
    v_rcp_f32 v26, v26
    v_rcp_f32 v27, v27
    s_nop 0
    v_pk_mul_f32 v[112:113], v[112:113], v[20:21]
    v_pk_mul_f32 v[114:115], v[114:115], v[22:23]
    v_pk_mul_f32 v[116:117], v[116:117], v[24:25]
    v_pk_mul_f32 v[118:119], v[118:119], v[26:27]
    v_cvt_pk_bf16_f32 v172, v112, v113
    v_cvt_pk_bf16_f32 v173, v114, v115
    v_cvt_pk_bf16_f32 v174, v116, v117
    v_cvt_pk_bf16_f32 v175, v118, v119
    s_add_u32 s77, s71, 177152
    buffer_store_dwordx4 v[172:175], v2, s[36:39], s77 offen sc1
    s_lshl_b32 s72, s2, 10
    s_lshl_b32 s73, s13, 9
    s_add_u32 s72, s72, s73
    v_lshl_add_u32 v12, v5, 2, s72
    v_lshl_add_u32 v12, v6, 7, v12
    s_lshl_b32 s72, s11, 12
    s_add_u32 s72, s72, 147456
    v_lshl_add_u32 v13, v5, 7, s72
    v_and_b32 v14, 7, v1
    v_lshlrev_b32 v15, 1, v6
    v_xor_b32 v14, v14, v15
    v_lshl_add_u32 v13, v14, 4, v13
    v_xor_b32 v14, 16, v13
    v_xor_b32 v15, 64, v13
    v_xor_b32 v8, 80, v13
    v_mov_b32 v16, v136
    v_mov_b32 v17, v137
    v_mov_b32 v18, v138
    v_mov_b32 v19, v139
    s_lshl_b32 s74, s13, 13
    v_add_u32 v96, s74, v2
    v_bfe_u32 v20, v1, 2, 2
    v_lshl_add_u32 v21, v6, 3, v20
    v_lshlrev_b32 v21, 7, v21
    v_lshrrev_b32 v20, 1, v20
    v_xor_b32 v20, s2, v20
    v_lshl_add_u32 v21, v20, 6, v21
    v_bfe_u32 v20, v1, 4, 1
    v_lshl_add_u32 v21, v20, 5, v21
    v_and_b32 v20, 3, v1
    v_lshl_add_u32 v99, v20, 3, v21
    s_lshl_b32 s74, s2, 12
    v_lshl_add_u32 v21, v5, 7, s74
    v_lshl_add_u32 v21, v6, 13, v21
    v_bfe_u32 v20, v1, 1, 3
    v_xor_b32 v22, 0, v20
    v_lshl_add_u32 v102, v22, 4, v21
    v_xor_b32 v22, 1, v20
    v_lshl_add_u32 v105, v22, 4, v21
    v_xor_b32 v22, 2, v20
    v_lshl_add_u32 v108, v22, 4, v21
    v_xor_b32 v22, 3, v20
    v_lshl_add_u32 v111, v22, 4, v21
    v_xor_b32 v22, 4, v20
    v_lshl_add_u32 v114, v22, 4, v21
    v_xor_b32 v22, 5, v20
    v_lshl_add_u32 v117, v22, 4, v21
    v_xor_b32 v22, 6, v20
    v_lshl_add_u32 v120, v22, 4, v21
    v_xor_b32 v22, 7, v20
    v_lshl_add_u32 v123, v22, 4, v21
    v_add_u32 v97, 0x10000, v96
    v_add_u32 v98, 0x20000, v96
    v_add_u32 v100, 0x10000, v99
    v_add_u32 v101, 0x20000, v99
    v_add_u32 v103, 0x10000, v102
    v_add_u32 v104, 0x20000, v102
    v_add_u32 v106, 0x10000, v105
    v_add_u32 v107, 0x20000, v105
    v_add_u32 v109, 0x10000, v108
    v_add_u32 v110, 0x20000, v108
    v_add_u32 v112, 0x10000, v111
    v_add_u32 v113, 0x20000, v111
    v_add_u32 v115, 0x10000, v114
    v_add_u32 v116, 0x20000, v114
    v_add_u32 v118, 0x10000, v117
    v_add_u32 v119, 0x20000, v117
    v_add_u32 v121, 0x10000, v120
    v_add_u32 v122, 0x20000, v120
    v_add_u32 v124, 0x10000, v123
    v_add_u32 v125, 0x20000, v123
    s_lshl_b32 s74, s8, 6
    s_lshl_b32 s82, s13, 5
    s_add_u32 s82, s82, s74
    s_lshl_b32 s74, s9, 6
    s_lshl_b32 s83, s2, 5
    s_add_u32 s83, s83, s74
    s_mul_i32 s84, s82, 896
    s_lshl_b32 s75, s83, 1
    s_add_u32 s84, s84, s75
    s_lshl_b32 s85, s82, 4
    s_add_u32 s85, s85, 11534336
    s_mul_i32 s68, s82, 1792
    s_lshl_b32 s76, s83, 2
    s_add_u32 s68, s68, s76
    s_lshl_b32 s74, s13, 12
    s_lshl_b32 s75, s2, 6
    s_add_u32 s74, s74, s75
    v_lshl_add_u32 v80, v6, 11, s74
    v_lshl_add_u32 v80, v5, 1, v80
    s_lshl_b32 s74, s13, 9
    v_lshl_add_u32 v84, v6, 8, s74
    v_add_u32 v85, s83, v5
    v_lshlrev_b32 v85, 1, v85
    v_mul_u32_u24 v127, 28672, v6
    v_lshl_add_u32 v127, v5, 2, v127
    global_load_ushort v126, v85, s[66:67]
    s_waitcnt lgkmcnt(0)
    s_barrier
    ds_read_b128 a[0:3], v96 offset:49152
    ds_read_b64_tr_b16 a[4:5], v100 offset:16384
    ds_read_b64_tr_b16 a[6:7], v100 offset:16896
    ds_read_b128 a[8:11], v96 offset:50176
    ds_read_b64_tr_b16 a[12:13], v100 offset:18432
    ds_read_b64_tr_b16 a[14:15], v100 offset:18944
    ds_read_b128 a[16:19], v96 offset:51200
    ds_read_b64_tr_b16 a[20:21], v100 offset:20480
    ds_read_b64_tr_b16 a[22:23], v100 offset:20992
    ds_read_b128 a[24:27], v96 offset:52224
    ds_read_b64_tr_b16 a[28:29], v100 offset:22528
    ds_read_b64_tr_b16 a[30:31], v100 offset:23040
    s_waitcnt lgkmcnt(9)
    v_mfma_f32_32x32x16_bf16 v[64:79], a[0:3], a[4:7], 0
    ds_read_b128 a[32:35], v96 offset:53248
    ds_read_b64_tr_b16 a[36:37], v100 offset:24576
    ds_read_b64_tr_b16 a[38:39], v100 offset:25088
    ds_read_b128 a[40:43], v96 offset:54272
    ds_read_b64_tr_b16 a[44:45], v100 offset:26624
    ds_read_b64_tr_b16 a[46:47], v100 offset:27136
    ds_read_b32 v0, v12 offset:11264
    ds_read_b32 v7, v12 offset:11520
    s_waitcnt lgkmcnt(12)
    v_mfma_f32_32x32x16_bf16 v[176:191], a[8:11], a[12:15], 0
    ds_read_b128 a[48:51], v96 offset:55296
    ds_read_b64_tr_b16 a[52:53], v100 offset:28672
    ds_read_b64_tr_b16 a[54:55], v100 offset:29184
    ds_read_b128 a[56:59], v96 offset:56320
    ds_read_b64_tr_b16 a[60:61], v100 offset:30720
    ds_read_b64_tr_b16 a[62:63], v100 offset:31232
    s_waitcnt lgkmcnt(15)
    v_mfma_f32_32x32x16_bf16 v[64:79], a[16:19], a[20:23], v[64:79]
    s_waitcnt lgkmcnt(12)
    v_mfma_f32_32x32x16_bf16 v[176:191], a[24:27], a[28:31], v[176:191]
    s_waitcnt lgkmcnt(0)
    s_barrier
    v_mfma_f32_32x32x16_bf16 v[64:79], a[32:35], a[36:39], v[64:79]
    ds_read_b128 a[0:3], v97 offset:0
    ds_read_b64_tr_b16 a[4:5], v100 offset:32768
    ds_read_b64_tr_b16 a[6:7], v100 offset:33280
    v_fma_f32 v32, v16, v0, v32
    v_fma_f32 v48, v16, v7, v48
    v_fmac_f32_dpp v32, v0, v17 quad_perm:[1,0,3,2] row_mask:0xf bank_mask:0xf
    v_fmac_f32_dpp v48, v7, v17 quad_perm:[1,0,3,2] row_mask:0xf bank_mask:0xf
    v_mfma_f32_32x32x16_bf16 v[176:191], a[40:43], a[44:47], v[176:191]
    ds_read_b128 a[8:11], v97 offset:1024
    ds_read_b64_tr_b16 a[12:13], v100 offset:34816
    ds_read_b64_tr_b16 a[14:15], v100 offset:35328
    v_fma_f32 v33, v16, v32, v33
    v_fma_f32 v49, v16, v48, v49
    v_fmac_f32_dpp v33, v32, v17 quad_perm:[1,0,3,2] row_mask:0xf bank_mask:0xf
    v_fmac_f32_dpp v49, v48, v17 quad_perm:[1,0,3,2] row_mask:0xf bank_mask:0xf
    v_mfma_f32_32x32x16_bf16 v[64:79], a[48:51], a[52:55], v[64:79]
    ds_read_b128 a[16:19], v97 offset:2048
    ds_read_b64_tr_b16 a[20:21], v100 offset:36864
    ds_read_b64_tr_b16 a[22:23], v100 offset:37376
    v_fma_f32 v34, v16, v33, v34
    v_fma_f32 v50, v16, v49, v50
    v_fmac_f32_dpp v34, v33, v17 quad_perm:[1,0,3,2] row_mask:0xf bank_mask:0xf
    v_fmac_f32_dpp v50, v49, v17 quad_perm:[1,0,3,2] row_mask:0xf bank_mask:0xf
    v_mfma_f32_32x32x16_bf16 v[176:191], a[56:59], a[60:63], v[176:191]
    ds_read_b128 a[24:27], v97 offset:3072
    ds_read_b64_tr_b16 a[28:29], v100 offset:38912
    ds_read_b64_tr_b16 a[30:31], v100 offset:39424
    v_fma_f32 v35, v16, v34, v35
    v_fma_f32 v51, v16, v50, v51
    v_fmac_f32_dpp v35, v34, v17 quad_perm:[1,0,3,2] row_mask:0xf bank_mask:0xf
    v_fmac_f32_dpp v51, v50, v17 quad_perm:[1,0,3,2] row_mask:0xf bank_mask:0xf
    s_waitcnt lgkmcnt(9)
    v_mfma_f32_32x32x16_bf16 v[64:79], a[0:3], a[4:7], v[64:79]
    ds_read_b128 a[32:35], v97 offset:4096
    ds_read_b64_tr_b16 a[36:37], v100 offset:40960
    ds_read_b64_tr_b16 a[38:39], v100 offset:41472
    ds_read_b128 a[40:43], v97 offset:5120
    ds_read_b64_tr_b16 a[44:45], v100 offset:43008
    ds_read_b64_tr_b16 a[46:47], v100 offset:43520
    v_fma_f32 v36, v16, v35, v36
    v_fma_f32 v52, v16, v51, v52
    v_fmac_f32_dpp v36, v35, v17 quad_perm:[1,0,3,2] row_mask:0xf bank_mask:0xf
    v_fmac_f32_dpp v52, v51, v17 quad_perm:[1,0,3,2] row_mask:0xf bank_mask:0xf
    s_waitcnt lgkmcnt(12)
    v_mfma_f32_32x32x16_bf16 v[176:191], a[8:11], a[12:15], v[176:191]
    ds_read_b128 a[48:51], v97 offset:6144
    ds_read_b64_tr_b16 a[52:53], v100 offset:45056
    ds_read_b64_tr_b16 a[54:55], v100 offset:45568
    ds_read_b128 a[56:59], v97 offset:7168
    ds_read_b64_tr_b16 a[60:61], v100 offset:47104
    ds_read_b64_tr_b16 a[62:63], v100 offset:47616
    v_fma_f32 v37, v16, v36, v37
    v_fma_f32 v53, v16, v52, v53
    v_fmac_f32_dpp v37, v36, v17 quad_perm:[1,0,3,2] row_mask:0xf bank_mask:0xf
    v_fmac_f32_dpp v53, v52, v17 quad_perm:[1,0,3,2] row_mask:0xf bank_mask:0xf
    s_waitcnt lgkmcnt(15)
    v_mfma_f32_32x32x16_bf16 v[64:79], a[16:19], a[20:23], v[64:79]
    v_fma_f32 v38, v16, v37, v38
    v_fma_f32 v54, v16, v53, v54
    v_fmac_f32_dpp v38, v37, v17 quad_perm:[1,0,3,2] row_mask:0xf bank_mask:0xf
    v_fmac_f32_dpp v54, v53, v17 quad_perm:[1,0,3,2] row_mask:0xf bank_mask:0xf
    s_waitcnt lgkmcnt(12)
    v_mfma_f32_32x32x16_bf16 v[176:191], a[24:27], a[28:31], v[176:191]
    v_fma_f32 v39, v16, v38, v39
    v_fma_f32 v55, v16, v54, v55
    v_fmac_f32_dpp v39, v38, v17 quad_perm:[1,0,3,2] row_mask:0xf bank_mask:0xf
    v_fmac_f32_dpp v55, v54, v17 quad_perm:[1,0,3,2] row_mask:0xf bank_mask:0xf
    s_waitcnt lgkmcnt(0)
    s_waitcnt vmcnt(1)
    s_barrier
    v_mfma_f32_32x32x16_bf16 v[64:79], a[32:35], a[36:39], v[64:79]
    ds_read_b128 a[0:3], v96 offset:49152
    ds_read_b64_tr_b16 a[4:5], v100 offset:49152
    ds_read_b64_tr_b16 a[6:7], v100 offset:49664
    v_fma_f32 v40, v16, v39, v40
    v_fma_f32 v56, v16, v55, v56
    v_fmac_f32_dpp v40, v39, v17 quad_perm:[1,0,3,2] row_mask:0xf bank_mask:0xf
    v_fmac_f32_dpp v56, v55, v17 quad_perm:[1,0,3,2] row_mask:0xf bank_mask:0xf
    v_mfma_f32_32x32x16_bf16 v[176:191], a[40:43], a[44:47], v[176:191]
    ds_read_b128 a[8:11], v96 offset:50176
    ds_read_b64_tr_b16 a[12:13], v100 offset:51200
    ds_read_b64_tr_b16 a[14:15], v100 offset:51712
    v_fma_f32 v41, v16, v40, v41
    v_fma_f32 v57, v16, v56, v57
    v_fmac_f32_dpp v41, v40, v17 quad_perm:[1,0,3,2] row_mask:0xf bank_mask:0xf
    v_fmac_f32_dpp v57, v56, v17 quad_perm:[1,0,3,2] row_mask:0xf bank_mask:0xf
    v_mfma_f32_32x32x16_bf16 v[64:79], a[48:51], a[52:55], v[64:79]
    ds_read_b128 a[16:19], v96 offset:51200
    ds_read_b64_tr_b16 a[20:21], v100 offset:53248
    ds_read_b64_tr_b16 a[22:23], v100 offset:53760
    v_fma_f32 v42, v16, v41, v42
    v_fma_f32 v58, v16, v57, v58
    v_fmac_f32_dpp v42, v41, v17 quad_perm:[1,0,3,2] row_mask:0xf bank_mask:0xf
    v_fmac_f32_dpp v58, v57, v17 quad_perm:[1,0,3,2] row_mask:0xf bank_mask:0xf
    v_mfma_f32_32x32x16_bf16 v[176:191], a[56:59], a[60:63], v[176:191]
    ds_read_b128 a[24:27], v96 offset:52224
    ds_read_b64_tr_b16 a[28:29], v100 offset:55296
    ds_read_b64_tr_b16 a[30:31], v100 offset:55808
    v_fma_f32 v43, v16, v42, v43
    v_fma_f32 v59, v16, v58, v59
    v_fmac_f32_dpp v43, v42, v17 quad_perm:[1,0,3,2] row_mask:0xf bank_mask:0xf
    v_fmac_f32_dpp v59, v58, v17 quad_perm:[1,0,3,2] row_mask:0xf bank_mask:0xf
    s_waitcnt lgkmcnt(9)
    v_mfma_f32_32x32x16_bf16 v[64:79], a[0:3], a[4:7], v[64:79]
    ds_read_b128 a[32:35], v96 offset:53248
    ds_read_b64_tr_b16 a[36:37], v100 offset:57344
    ds_read_b64_tr_b16 a[38:39], v100 offset:57856
    ds_read_b128 a[40:43], v96 offset:54272
    ds_read_b64_tr_b16 a[44:45], v100 offset:59392
    ds_read_b64_tr_b16 a[46:47], v100 offset:59904
    v_fma_f32 v44, v16, v43, v44
    v_fma_f32 v60, v16, v59, v60
    v_fmac_f32_dpp v44, v43, v17 quad_perm:[1,0,3,2] row_mask:0xf bank_mask:0xf
    v_fmac_f32_dpp v60, v59, v17 quad_perm:[1,0,3,2] row_mask:0xf bank_mask:0xf
    s_waitcnt lgkmcnt(12)
    v_mfma_f32_32x32x16_bf16 v[176:191], a[8:11], a[12:15], v[176:191]
    ds_read_b128 a[48:51], v96 offset:55296
    ds_read_b64_tr_b16 a[52:53], v100 offset:61440
    ds_read_b64_tr_b16 a[54:55], v100 offset:61952
    ds_read_b128 a[56:59], v96 offset:56320
    ds_read_b64_tr_b16 a[60:61], v100 offset:63488
    ds_read_b64_tr_b16 a[62:63], v100 offset:64000
    v_fma_f32 v45, v16, v44, v45
    v_fma_f32 v61, v16, v60, v61
    v_fmac_f32_dpp v45, v44, v17 quad_perm:[1,0,3,2] row_mask:0xf bank_mask:0xf
    v_fmac_f32_dpp v61, v60, v17 quad_perm:[1,0,3,2] row_mask:0xf bank_mask:0xf
    s_waitcnt lgkmcnt(15)
    v_mfma_f32_32x32x16_bf16 v[64:79], a[16:19], a[20:23], v[64:79]
    v_fma_f32 v46, v16, v45, v46
    v_fma_f32 v62, v16, v61, v62
    v_fmac_f32_dpp v46, v45, v17 quad_perm:[1,0,3,2] row_mask:0xf bank_mask:0xf
    v_fmac_f32_dpp v62, v61, v17 quad_perm:[1,0,3,2] row_mask:0xf bank_mask:0xf
    s_waitcnt lgkmcnt(12)
    v_mfma_f32_32x32x16_bf16 v[176:191], a[24:27], a[28:31], v[176:191]
    v_fma_f32 v47, v16, v46, v47
    v_fma_f32 v63, v16, v62, v63
    v_fmac_f32_dpp v47, v46, v17 quad_perm:[1,0,3,2] row_mask:0xf bank_mask:0xf
    v_fmac_f32_dpp v63, v62, v17 quad_perm:[1,0,3,2] row_mask:0xf bank_mask:0xf
    s_waitcnt lgkmcnt(0)
    s_barrier
    v_mfma_f32_32x32x16_bf16 v[64:79], a[32:35], a[36:39], v[64:79]
    ds_read_b128 a[0:3], v97 offset:16384
    ds_read_b64_tr_b16 a[4:5], v101 offset:0
    ds_read_b64_tr_b16 a[6:7], v101 offset:512
    v_mul_f32 v20, v18, v32
    v_mul_f32 v21, v18, v33
    v_mul_f32 v22, v18, v34
    v_mul_f32 v23, v18, v35
    v_mfma_f32_32x32x16_bf16 v[176:191], a[40:43], a[44:47], v[176:191]
    ds_read_b128 a[8:11], v97 offset:17408
    ds_read_b64_tr_b16 a[12:13], v101 offset:2048
    ds_read_b64_tr_b16 a[14:15], v101 offset:2560
    v_mul_f32 v24, v18, v36
    v_mul_f32 v25, v18, v37
    v_mul_f32 v26, v18, v38
    v_mul_f32 v27, v18, v39
    v_mfma_f32_32x32x16_bf16 v[64:79], a[48:51], a[52:55], v[64:79]
    ds_read_b128 a[16:19], v97 offset:18432
    ds_read_b64_tr_b16 a[20:21], v101 offset:4096
    ds_read_b64_tr_b16 a[22:23], v101 offset:4608
    v_fmac_f32_dpp v20, v32, v19 quad_perm:[1,0,3,2] row_mask:0xf bank_mask:0xf
    v_fmac_f32_dpp v21, v33, v19 quad_perm:[1,0,3,2] row_mask:0xf bank_mask:0xf
    v_fmac_f32_dpp v22, v34, v19 quad_perm:[1,0,3,2] row_mask:0xf bank_mask:0xf
    v_fmac_f32_dpp v23, v35, v19 quad_perm:[1,0,3,2] row_mask:0xf bank_mask:0xf
    v_mfma_f32_32x32x16_bf16 v[176:191], a[56:59], a[60:63], v[176:191]
    ds_read_b128 a[24:27], v97 offset:19456
    ds_read_b64_tr_b16 a[28:29], v101 offset:6144
    ds_read_b64_tr_b16 a[30:31], v101 offset:6656
    v_fmac_f32_dpp v24, v36, v19 quad_perm:[1,0,3,2] row_mask:0xf bank_mask:0xf
    v_fmac_f32_dpp v25, v37, v19 quad_perm:[1,0,3,2] row_mask:0xf bank_mask:0xf
    v_fmac_f32_dpp v26, v38, v19 quad_perm:[1,0,3,2] row_mask:0xf bank_mask:0xf
    v_fmac_f32_dpp v27, v39, v19 quad_perm:[1,0,3,2] row_mask:0xf bank_mask:0xf
    s_waitcnt lgkmcnt(9)
    v_mfma_f32_32x32x16_bf16 v[64:79], a[0:3], a[4:7], v[64:79]
    ds_read_b128 a[32:35], v97 offset:20480
    ds_read_b64_tr_b16 a[36:37], v101 offset:8192
    ds_read_b64_tr_b16 a[38:39], v101 offset:8704
    ds_read_b128 a[40:43], v97 offset:21504
    ds_read_b64_tr_b16 a[44:45], v101 offset:10240
    ds_read_b64_tr_b16 a[46:47], v101 offset:10752
    v_cvt_pk_bf16_f32 v32, v20, v21
    v_cvt_pk_bf16_f32 v33, v22, v23
    v_cvt_pk_bf16_f32 v34, v24, v25
    v_cvt_pk_bf16_f32 v35, v26, v27
    s_waitcnt lgkmcnt(12)
    v_mfma_f32_32x32x16_bf16 v[176:191], a[8:11], a[12:15], v[176:191]
    ds_read_b128 a[48:51], v97 offset:22528
    ds_read_b64_tr_b16 a[52:53], v101 offset:12288
    ds_read_b64_tr_b16 a[54:55], v101 offset:12800
    ds_read_b128 a[56:59], v97 offset:23552
    ds_read_b64_tr_b16 a[60:61], v101 offset:14336
    ds_read_b64_tr_b16 a[62:63], v101 offset:14848
    v_mul_f32 v20, v18, v40
    v_mul_f32 v21, v18, v41
    v_mul_f32 v22, v18, v42
    v_mul_f32 v23, v18, v43
    s_waitcnt lgkmcnt(15)
    v_mfma_f32_32x32x16_bf16 v[64:79], a[16:19], a[20:23], v[64:79]
    v_mul_f32 v24, v18, v44
    v_mul_f32 v25, v18, v45
    v_mul_f32 v26, v18, v46
    v_mul_f32 v27, v18, v47
    s_waitcnt lgkmcnt(12)
    v_mfma_f32_32x32x16_bf16 v[176:191], a[24:27], a[28:31], v[176:191]
    v_fmac_f32_dpp v20, v40, v19 quad_perm:[1,0,3,2] row_mask:0xf bank_mask:0xf
    v_fmac_f32_dpp v21, v41, v19 quad_perm:[1,0,3,2] row_mask:0xf bank_mask:0xf
    v_fmac_f32_dpp v22, v42, v19 quad_perm:[1,0,3,2] row_mask:0xf bank_mask:0xf
    v_fmac_f32_dpp v23, v43, v19 quad_perm:[1,0,3,2] row_mask:0xf bank_mask:0xf
    s_waitcnt lgkmcnt(0)
    s_barrier
    v_mfma_f32_32x32x16_bf16 v[64:79], a[32:35], a[36:39], v[64:79]
    ds_read_b128 a[0:3], v97 offset:0
    ds_read_b64_tr_b16 a[4:5], v99 offset:16384
    ds_read_b64_tr_b16 a[6:7], v99 offset:16896
    v_fmac_f32_dpp v24, v44, v19 quad_perm:[1,0,3,2] row_mask:0xf bank_mask:0xf
    v_fmac_f32_dpp v25, v45, v19 quad_perm:[1,0,3,2] row_mask:0xf bank_mask:0xf
    v_fmac_f32_dpp v26, v46, v19 quad_perm:[1,0,3,2] row_mask:0xf bank_mask:0xf
    v_fmac_f32_dpp v27, v47, v19 quad_perm:[1,0,3,2] row_mask:0xf bank_mask:0xf
    v_mfma_f32_32x32x16_bf16 v[176:191], a[40:43], a[44:47], v[176:191]
    ds_read_b128 a[8:11], v97 offset:1024
    ds_read_b64_tr_b16 a[12:13], v99 offset:18432
    ds_read_b64_tr_b16 a[14:15], v99 offset:18944
    v_cvt_pk_bf16_f32 v36, v20, v21
    v_cvt_pk_bf16_f32 v37, v22, v23
    v_cvt_pk_bf16_f32 v38, v24, v25
    v_cvt_pk_bf16_f32 v39, v26, v27
    v_mfma_f32_32x32x16_bf16 v[64:79], a[48:51], a[52:55], v[64:79]
    ds_read_b128 a[16:19], v97 offset:2048
    ds_read_b64_tr_b16 a[20:21], v99 offset:20480
    ds_read_b64_tr_b16 a[22:23], v99 offset:20992
    v_mul_f32 v20, v18, v48
    v_mul_f32 v21, v18, v49
    v_mul_f32 v22, v18, v50
    v_mul_f32 v23, v18, v51
    v_mfma_f32_32x32x16_bf16 v[176:191], a[56:59], a[60:63], v[176:191]
    ds_read_b128 a[24:27], v97 offset:3072
    ds_read_b64_tr_b16 a[28:29], v99 offset:22528
    ds_read_b64_tr_b16 a[30:31], v99 offset:23040
    v_mul_f32 v24, v18, v52
    v_mul_f32 v25, v18, v53
    v_mul_f32 v26, v18, v54
    v_mul_f32 v27, v18, v55
    s_waitcnt lgkmcnt(9)
    v_mfma_f32_32x32x16_bf16 v[64:79], a[0:3], a[4:7], v[64:79]
    ds_read_b128 a[32:35], v97 offset:4096
    ds_read_b64_tr_b16 a[36:37], v99 offset:24576
    ds_read_b64_tr_b16 a[38:39], v99 offset:25088
    ds_read_b128 a[40:43], v97 offset:5120
    ds_read_b64_tr_b16 a[44:45], v99 offset:26624
    ds_read_b64_tr_b16 a[46:47], v99 offset:27136
    v_fmac_f32_dpp v20, v48, v19 quad_perm:[1,0,3,2] row_mask:0xf bank_mask:0xf
    v_fmac_f32_dpp v21, v49, v19 quad_perm:[1,0,3,2] row_mask:0xf bank_mask:0xf
    v_fmac_f32_dpp v22, v50, v19 quad_perm:[1,0,3,2] row_mask:0xf bank_mask:0xf
    v_fmac_f32_dpp v23, v51, v19 quad_perm:[1,0,3,2] row_mask:0xf bank_mask:0xf
    s_waitcnt lgkmcnt(12)
    v_mfma_f32_32x32x16_bf16 v[176:191], a[8:11], a[12:15], v[176:191]
    ds_read_b128 a[48:51], v97 offset:6144
    ds_read_b64_tr_b16 a[52:53], v99 offset:28672
    ds_read_b64_tr_b16 a[54:55], v99 offset:29184
    ds_read_b128 a[56:59], v97 offset:7168
    ds_read_b64_tr_b16 a[60:61], v99 offset:30720
    ds_read_b64_tr_b16 a[62:63], v99 offset:31232
    v_fmac_f32_dpp v24, v52, v19 quad_perm:[1,0,3,2] row_mask:0xf bank_mask:0xf
    v_fmac_f32_dpp v25, v53, v19 quad_perm:[1,0,3,2] row_mask:0xf bank_mask:0xf
    v_fmac_f32_dpp v26, v54, v19 quad_perm:[1,0,3,2] row_mask:0xf bank_mask:0xf
    v_fmac_f32_dpp v27, v55, v19 quad_perm:[1,0,3,2] row_mask:0xf bank_mask:0xf
    s_waitcnt lgkmcnt(15)
    v_mfma_f32_32x32x16_bf16 v[64:79], a[16:19], a[20:23], v[64:79]
    v_cvt_pk_bf16_f32 v40, v20, v21
    v_cvt_pk_bf16_f32 v41, v22, v23
    v_cvt_pk_bf16_f32 v42, v24, v25
    v_cvt_pk_bf16_f32 v43, v26, v27
    s_waitcnt lgkmcnt(12)
    v_mfma_f32_32x32x16_bf16 v[176:191], a[24:27], a[28:31], v[176:191]
    v_mul_f32 v20, v18, v56
    v_mul_f32 v21, v18, v57
    v_mul_f32 v22, v18, v58
    v_mul_f32 v23, v18, v59
    s_waitcnt lgkmcnt(0)
    s_barrier
    v_mfma_f32_32x32x16_bf16 v[64:79], a[32:35], a[36:39], v[64:79]
    ds_read_b128 a[0:3], v97 offset:32768
    ds_read_b64_tr_b16 a[4:5], v99 offset:32768
    ds_read_b64_tr_b16 a[6:7], v99 offset:33280
    v_mul_f32 v24, v18, v60
    v_mul_f32 v25, v18, v61
    v_mul_f32 v26, v18, v62
    v_mul_f32 v27, v18, v63
    v_mfma_f32_32x32x16_bf16 v[176:191], a[40:43], a[44:47], v[176:191]
    ds_read_b128 a[8:11], v97 offset:33792
    ds_read_b64_tr_b16 a[12:13], v99 offset:34816
    ds_read_b64_tr_b16 a[14:15], v99 offset:35328
    v_fmac_f32_dpp v20, v56, v19 quad_perm:[1,0,3,2] row_mask:0xf bank_mask:0xf
    v_fmac_f32_dpp v21, v57, v19 quad_perm:[1,0,3,2] row_mask:0xf bank_mask:0xf
    v_fmac_f32_dpp v22, v58, v19 quad_perm:[1,0,3,2] row_mask:0xf bank_mask:0xf
    v_fmac_f32_dpp v23, v59, v19 quad_perm:[1,0,3,2] row_mask:0xf bank_mask:0xf
    v_mfma_f32_32x32x16_bf16 v[64:79], a[48:51], a[52:55], v[64:79]
    ds_read_b128 a[16:19], v97 offset:34816
    ds_read_b64_tr_b16 a[20:21], v99 offset:36864
    ds_read_b64_tr_b16 a[22:23], v99 offset:37376
    v_fmac_f32_dpp v24, v60, v19 quad_perm:[1,0,3,2] row_mask:0xf bank_mask:0xf
    v_fmac_f32_dpp v25, v61, v19 quad_perm:[1,0,3,2] row_mask:0xf bank_mask:0xf
    v_fmac_f32_dpp v26, v62, v19 quad_perm:[1,0,3,2] row_mask:0xf bank_mask:0xf
    v_fmac_f32_dpp v27, v63, v19 quad_perm:[1,0,3,2] row_mask:0xf bank_mask:0xf
    v_mfma_f32_32x32x16_bf16 v[176:191], a[56:59], a[60:63], v[176:191]
    ds_read_b128 a[24:27], v97 offset:35840
    ds_read_b64_tr_b16 a[28:29], v99 offset:38912
    ds_read_b64_tr_b16 a[30:31], v99 offset:39424
    v_cvt_pk_bf16_f32 v44, v20, v21
    v_cvt_pk_bf16_f32 v45, v22, v23
    v_cvt_pk_bf16_f32 v46, v24, v25
    v_cvt_pk_bf16_f32 v47, v26, v27
    s_waitcnt lgkmcnt(9)
    v_mfma_f32_32x32x16_bf16 v[64:79], a[0:3], a[4:7], v[64:79]
    ds_read_b128 a[32:35], v97 offset:36864
    ds_read_b64_tr_b16 a[36:37], v99 offset:40960
    ds_read_b64_tr_b16 a[38:39], v99 offset:41472
    ds_read_b128 a[40:43], v97 offset:37888
    ds_read_b64_tr_b16 a[44:45], v99 offset:43008
    ds_read_b64_tr_b16 a[46:47], v99 offset:43520
    ds_write_b128 v13, v[32:35]
    ds_write_b128 v14, v[36:39]
    ds_write_b128 v15, v[40:43]
    ds_write_b128 v8, v[44:47]
    s_waitcnt lgkmcnt(12)
    v_mfma_f32_32x32x16_bf16 v[176:191], a[8:11], a[12:15], v[176:191]
    ds_read_b128 a[48:51], v97 offset:38912
    ds_read_b64_tr_b16 a[52:53], v99 offset:45056
    ds_read_b64_tr_b16 a[54:55], v99 offset:45568
    ds_read_b128 a[56:59], v97 offset:39936
    ds_read_b64_tr_b16 a[60:61], v99 offset:47104
    ds_read_b64_tr_b16 a[62:63], v99 offset:47616
    s_waitcnt lgkmcnt(15)
    v_mfma_f32_32x32x16_bf16 v[64:79], a[16:19], a[20:23], v[64:79]
    s_waitcnt lgkmcnt(12)
    v_mfma_f32_32x32x16_bf16 v[176:191], a[24:27], a[28:31], v[176:191]
    s_waitcnt lgkmcnt(0)
    s_barrier
    v_mfma_f32_32x32x16_bf16 v[64:79], a[32:35], a[36:39], v[64:79]
    ds_read_b128 a[0:3], v96 offset:49152
    ds_read_b64_tr_b16 a[4:5], v100 offset:49152
    ds_read_b64_tr_b16 a[6:7], v100 offset:49664
    v_mfma_f32_32x32x16_bf16 v[176:191], a[40:43], a[44:47], v[176:191]
    ds_read_b128 a[8:11], v96 offset:50176
    ds_read_b64_tr_b16 a[12:13], v100 offset:51200
    ds_read_b64_tr_b16 a[14:15], v100 offset:51712
    v_mfma_f32_32x32x16_bf16 v[64:79], a[48:51], a[52:55], v[64:79]
    ds_read_b128 a[16:19], v96 offset:51200
    ds_read_b64_tr_b16 a[20:21], v100 offset:53248
    ds_read_b64_tr_b16 a[22:23], v100 offset:53760
    v_mfma_f32_32x32x16_bf16 v[176:191], a[56:59], a[60:63], v[176:191]
    ds_read_b128 a[24:27], v96 offset:52224
    ds_read_b64_tr_b16 a[28:29], v100 offset:55296
    ds_read_b64_tr_b16 a[30:31], v100 offset:55808
    s_waitcnt lgkmcnt(9)
    v_mfma_f32_32x32x16_bf16 v[64:79], a[0:3], a[4:7], v[64:79]
    ds_read_b128 a[32:35], v96 offset:53248
    ds_read_b64_tr_b16 a[36:37], v100 offset:57344
    ds_read_b64_tr_b16 a[38:39], v100 offset:57856
    ds_read_b128 a[40:43], v96 offset:54272
    ds_read_b64_tr_b16 a[44:45], v100 offset:59392
    ds_read_b64_tr_b16 a[46:47], v100 offset:59904
    ds_read_u16 v128, v80 offset:0
    ds_read_b64 v[144:145], v84 offset:8192
    ds_read_u16 v129, v80 offset:128
    s_waitcnt lgkmcnt(12)
    v_mfma_f32_32x32x16_bf16 v[176:191], a[8:11], a[12:15], v[176:191]
    ds_read_b128 a[48:51], v96 offset:55296
    ds_read_b64_tr_b16 a[52:53], v100 offset:61440
    ds_read_b64_tr_b16 a[54:55], v100 offset:61952
    ds_read_b128 a[56:59], v96 offset:56320
    ds_read_b64_tr_b16 a[60:61], v100 offset:63488
    ds_read_b64_tr_b16 a[62:63], v100 offset:64000
    ds_read_b64 v[146:147], v84 offset:8208
    ds_read_u16 v130, v80 offset:256
    ds_read_b64 v[148:149], v84 offset:8224
    ds_read_u16 v131, v80 offset:384
    s_waitcnt lgkmcnt(15)
    v_mfma_f32_32x32x16_bf16 v[64:79], a[16:19], a[20:23], v[64:79]
    ds_read_b64 v[150:151], v84 offset:8240
    s_waitcnt lgkmcnt(12)
    v_mfma_f32_32x32x16_bf16 v[176:191], a[24:27], a[28:31], v[176:191]
    s_waitcnt lgkmcnt(0)
    s_barrier
    v_mfma_f32_32x32x16_bf16 v[64:79], a[32:35], a[36:39], v[64:79]
    ds_read_b128 a[0:3], v97 offset:0
    ds_read_b64_tr_b16 a[4:5], v100 offset:16384
    ds_read_b64_tr_b16 a[6:7], v100 offset:16896
    ds_read_u16 v132, v80 offset:512
    ds_read_b64 v[152:153], v84 offset:8256
    ds_read_u16 v133, v80 offset:640
    ds_read_b64 v[154:155], v84 offset:8272
    v_mfma_f32_32x32x16_bf16 v[176:191], a[40:43], a[44:47], v[176:191]
    ds_read_b128 a[8:11], v97 offset:1024
    ds_read_b64_tr_b16 a[12:13], v100 offset:18432
    ds_read_b64_tr_b16 a[14:15], v100 offset:18944
    ds_read_u16 v134, v80 offset:768
    ds_read_b64 v[156:157], v84 offset:8288
    ds_read_u16 v135, v80 offset:896
    ds_read_b64 v[158:159], v84 offset:8304
    v_mfma_f32_32x32x16_bf16 v[64:79], a[48:51], a[52:55], v[64:79]
    ds_read_b128 a[16:19], v97 offset:2048
    ds_read_b64_tr_b16 a[20:21], v100 offset:20480
    ds_read_b64_tr_b16 a[22:23], v100 offset:20992
    v_mfma_f32_32x32x16_bf16 v[176:191], a[56:59], a[60:63], v[176:191]
    ds_read_b128 a[24:27], v97 offset:3072
    ds_read_b64_tr_b16 a[28:29], v100 offset:22528
    ds_read_b64_tr_b16 a[30:31], v100 offset:23040
    s_waitcnt lgkmcnt(9)
    v_mfma_f32_32x32x16_bf16 v[64:79], a[0:3], a[4:7], v[64:79]
    ds_read_b128 a[32:35], v97 offset:4096
    ds_read_b64_tr_b16 a[36:37], v100 offset:24576
    ds_read_b64_tr_b16 a[38:39], v100 offset:25088
    ds_read_b128 a[40:43], v97 offset:5120
    ds_read_b64_tr_b16 a[44:45], v100 offset:26624
    ds_read_b64_tr_b16 a[46:47], v100 offset:27136
    s_waitcnt lgkmcnt(12)
    v_mfma_f32_32x32x16_bf16 v[176:191], a[8:11], a[12:15], v[176:191]
    ds_read_b128 a[48:51], v97 offset:6144
    ds_read_b64_tr_b16 a[52:53], v100 offset:28672
    ds_read_b64_tr_b16 a[54:55], v100 offset:29184
    ds_read_b128 a[56:59], v97 offset:7168
    ds_read_b64_tr_b16 a[60:61], v100 offset:30720
    ds_read_b64_tr_b16 a[62:63], v100 offset:31232
    s_waitcnt lgkmcnt(15)
    v_mfma_f32_32x32x16_bf16 v[64:79], a[16:19], a[20:23], v[64:79]
    s_waitcnt lgkmcnt(12)
    v_mfma_f32_32x32x16_bf16 v[176:191], a[24:27], a[28:31], v[176:191]
    s_waitcnt lgkmcnt(0)
    s_barrier
    v_mfma_f32_32x32x16_bf16 v[64:79], a[32:35], a[36:39], v[64:79]
    ds_read_b128 a[0:3], v96 offset:16384
    ds_read_b64_tr_b16 a[4:5], v101 offset:0
    ds_read_b64_tr_b16 a[6:7], v101 offset:512
    ds_read_u16 v136, v80 offset:1024
    ds_read_b64 v[160:161], v84 offset:8320
    ds_read_u16 v137, v80 offset:1152
    ds_read_b64 v[162:163], v84 offset:8336
    v_mfma_f32_32x32x16_bf16 v[176:191], a[40:43], a[44:47], v[176:191]
    ds_read_b128 a[8:11], v96 offset:17408
    ds_read_b64_tr_b16 a[12:13], v101 offset:2048
    ds_read_b64_tr_b16 a[14:15], v101 offset:2560
    ds_read_u16 v138, v80 offset:1280
    ds_read_b64 v[164:165], v84 offset:8352
    ds_read_u16 v139, v80 offset:1408
    ds_read_b64 v[166:167], v84 offset:8368
    v_mfma_f32_32x32x16_bf16 v[64:79], a[48:51], a[52:55], v[64:79]
    ds_read_b128 a[16:19], v96 offset:18432
    ds_read_b64_tr_b16 a[20:21], v101 offset:4096
    ds_read_b64_tr_b16 a[22:23], v101 offset:4608
    v_mfma_f32_32x32x16_bf16 v[176:191], a[56:59], a[60:63], v[176:191]
    ds_read_b128 a[24:27], v96 offset:19456
    ds_read_b64_tr_b16 a[28:29], v101 offset:6144
    ds_read_b64_tr_b16 a[30:31], v101 offset:6656
    s_waitcnt lgkmcnt(9)
    v_mfma_f32_32x32x16_bf16 v[64:79], a[0:3], a[4:7], v[64:79]
    ds_read_b128 a[32:35], v96 offset:20480
    ds_read_b64_tr_b16 a[36:37], v101 offset:8192
    ds_read_b64_tr_b16 a[38:39], v101 offset:8704
    ds_read_b128 a[40:43], v96 offset:21504
    ds_read_b64_tr_b16 a[44:45], v101 offset:10240
    ds_read_b64_tr_b16 a[46:47], v101 offset:10752
    s_waitcnt lgkmcnt(12)
    v_mfma_f32_32x32x16_bf16 v[176:191], a[8:11], a[12:15], v[176:191]
    ds_read_b128 a[48:51], v96 offset:22528
    ds_read_b64_tr_b16 a[52:53], v101 offset:12288
    ds_read_b64_tr_b16 a[54:55], v101 offset:12800
    ds_read_b128 a[56:59], v96 offset:23552
    ds_read_b64_tr_b16 a[60:61], v101 offset:14336
    ds_read_b64_tr_b16 a[62:63], v101 offset:14848
    s_waitcnt lgkmcnt(15)
    v_mfma_f32_32x32x16_bf16 v[64:79], a[16:19], a[20:23], v[64:79]
    s_waitcnt lgkmcnt(12)
    v_mfma_f32_32x32x16_bf16 v[176:191], a[24:27], a[28:31], v[176:191]
    s_waitcnt lgkmcnt(0)
    s_barrier
    v_mfma_f32_32x32x16_bf16 v[64:79], a[32:35], a[36:39], v[64:79]
    ds_read_b128 a[0:3], v97 offset:32768
    ds_read_b64_tr_b16 a[4:5], v99 offset:32768
    ds_read_b64_tr_b16 a[6:7], v99 offset:33280
    ds_read_u16 v140, v80 offset:1536
    ds_read_b64 v[168:169], v84 offset:8384
    ds_read_u16 v141, v80 offset:1664
    ds_read_b64 v[170:171], v84 offset:8400
    v_mfma_f32_32x32x16_bf16 v[176:191], a[40:43], a[44:47], v[176:191]
    ds_read_b128 a[8:11], v97 offset:33792
    ds_read_b64_tr_b16 a[12:13], v99 offset:34816
    ds_read_b64_tr_b16 a[14:15], v99 offset:35328
    ds_read_u16 v142, v80 offset:1792
    ds_read_b64 v[172:173], v84 offset:8416
    ds_read_u16 v143, v80 offset:1920
    ds_read_b64 v[174:175], v84 offset:8432
    v_mfma_f32_32x32x16_bf16 v[64:79], a[48:51], a[52:55], v[64:79]
    ds_read_b128 a[16:19], v97 offset:34816
    ds_read_b64_tr_b16 a[20:21], v99 offset:36864
    ds_read_b64_tr_b16 a[22:23], v99 offset:37376
    v_mfma_f32_32x32x16_bf16 v[176:191], a[56:59], a[60:63], v[176:191]
    ds_read_b128 a[24:27], v97 offset:35840
    ds_read_b64_tr_b16 a[28:29], v99 offset:38912
    ds_read_b64_tr_b16 a[30:31], v99 offset:39424
    s_waitcnt lgkmcnt(9)
    v_mfma_f32_32x32x16_bf16 v[64:79], a[0:3], a[4:7], v[64:79]
    ds_read_b128 a[32:35], v97 offset:36864
    ds_read_b64_tr_b16 a[36:37], v99 offset:40960
    ds_read_b64_tr_b16 a[38:39], v99 offset:41472
    ds_read_b128 a[40:43], v97 offset:37888
    ds_read_b64_tr_b16 a[44:45], v99 offset:43008
    ds_read_b64_tr_b16 a[46:47], v99 offset:43520
    s_waitcnt lgkmcnt(12)
    v_mfma_f32_32x32x16_bf16 v[176:191], a[8:11], a[12:15], v[176:191]
    ds_read_b128 a[48:51], v97 offset:38912
    ds_read_b64_tr_b16 a[52:53], v99 offset:45056
    ds_read_b64_tr_b16 a[54:55], v99 offset:45568
    ds_read_b128 a[56:59], v97 offset:39936
    ds_read_b64_tr_b16 a[60:61], v99 offset:47104
    ds_read_b64_tr_b16 a[62:63], v99 offset:47616
    s_waitcnt lgkmcnt(15)
    v_mfma_f32_32x32x16_bf16 v[64:79], a[16:19], a[20:23], v[64:79]
    s_waitcnt lgkmcnt(12)
    v_mfma_f32_32x32x16_bf16 v[176:191], a[24:27], a[28:31], v[176:191]
    s_waitcnt lgkmcnt(0)
    s_barrier
    v_mfma_f32_32x32x16_bf16 v[64:79], a[32:35], a[36:39], v[64:79]
    ds_read_b128 a[0:3], v96 offset:49152
    ds_read_b64_tr_b16 a[4:5], v100 offset:49152
    ds_read_b64_tr_b16 a[6:7], v100 offset:49664
    s_waitcnt vmcnt(0)
    v_lshlrev_b32 v126, 16, v126
    v_lshlrev_b32 v128, 16, v128
    v_mfma_f32_32x32x16_bf16 v[176:191], a[40:43], a[44:47], v[176:191]
    ds_read_b128 a[8:11], v96 offset:50176
    ds_read_b64_tr_b16 a[12:13], v100 offset:51200
    ds_read_b64_tr_b16 a[14:15], v100 offset:51712
    v_and_b32 v144, 0xffff0000, v144
    v_add_f32 v144, v128, v144
    v_lshlrev_b32 v129, 16, v129
    v_and_b32 v146, 0xffff0000, v146
    v_mfma_f32_32x32x16_bf16 v[64:79], a[48:51], a[52:55], v[64:79]
    ds_read_b128 a[16:19], v96 offset:51200
    ds_read_b64_tr_b16 a[20:21], v100 offset:53248
    ds_read_b64_tr_b16 a[22:23], v100 offset:53760
    v_add_f32 v146, v129, v146
    v_lshlrev_b32 v130, 16, v130
    v_and_b32 v148, 0xffff0000, v148
    v_add_f32 v148, v130, v148
    v_mfma_f32_32x32x16_bf16 v[176:191], a[56:59], a[60:63], v[176:191]
    ds_read_b128 a[24:27], v96 offset:52224
    ds_read_b64_tr_b16 a[28:29], v100 offset:55296
    ds_read_b64_tr_b16 a[30:31], v100 offset:55808
    v_lshlrev_b32 v131, 16, v131
    v_and_b32 v150, 0xffff0000, v150
    v_add_f32 v150, v131, v150
    v_lshlrev_b32 v132, 16, v132
    s_waitcnt lgkmcnt(9)
    v_mfma_f32_32x32x16_bf16 v[64:79], a[0:3], a[4:7], v[64:79]
    ds_read_b128 a[32:35], v96 offset:53248
    ds_read_b64_tr_b16 a[36:37], v100 offset:57344
    ds_read_b64_tr_b16 a[38:39], v100 offset:57856
    ds_read_b128 a[40:43], v96 offset:54272
    ds_read_b64_tr_b16 a[44:45], v100 offset:59392
    ds_read_b64_tr_b16 a[46:47], v100 offset:59904
    v_and_b32 v152, 0xffff0000, v152
    v_add_f32 v152, v132, v152
    v_lshlrev_b32 v133, 16, v133
    v_and_b32 v154, 0xffff0000, v154
    s_waitcnt lgkmcnt(12)
    v_mfma_f32_32x32x16_bf16 v[176:191], a[8:11], a[12:15], v[176:191]
    ds_read_b128 a[48:51], v96 offset:55296
    ds_read_b64_tr_b16 a[52:53], v100 offset:61440
    ds_read_b64_tr_b16 a[54:55], v100 offset:61952
    ds_read_b128 a[56:59], v96 offset:56320
    ds_read_b64_tr_b16 a[60:61], v100 offset:63488
    ds_read_b64_tr_b16 a[62:63], v100 offset:64000
    v_add_f32 v154, v133, v154
    v_lshlrev_b32 v134, 16, v134
    v_and_b32 v156, 0xffff0000, v156
    v_add_f32 v156, v134, v156
    s_waitcnt lgkmcnt(15)
    v_mfma_f32_32x32x16_bf16 v[64:79], a[16:19], a[20:23], v[64:79]
    v_lshlrev_b32 v135, 16, v135
    v_and_b32 v158, 0xffff0000, v158
    v_add_f32 v158, v135, v158
    v_lshlrev_b32 v136, 16, v136
    s_waitcnt lgkmcnt(12)
    v_mfma_f32_32x32x16_bf16 v[176:191], a[24:27], a[28:31], v[176:191]
    v_and_b32 v160, 0xffff0000, v160
    v_add_f32 v160, v136, v160
    v_lshlrev_b32 v137, 16, v137
    v_and_b32 v162, 0xffff0000, v162
    s_waitcnt lgkmcnt(0)
    s_barrier
    v_mfma_f32_32x32x16_bf16 v[64:79], a[32:35], a[36:39], v[64:79]
    ds_read_b128 a[0:3], v98 offset:16384
    ds_read_b64_tr_b16 a[4:5], v100 offset:0
    ds_read_b64_tr_b16 a[6:7], v100 offset:512
    v_add_f32 v162, v137, v162
    v_lshlrev_b32 v138, 16, v138
    v_and_b32 v164, 0xffff0000, v164
    v_add_f32 v164, v138, v164
    v_mfma_f32_32x32x16_bf16 v[176:191], a[40:43], a[44:47], v[176:191]
    ds_read_b128 a[8:11], v98 offset:17408
    ds_read_b64_tr_b16 a[12:13], v100 offset:2048
    ds_read_b64_tr_b16 a[14:15], v100 offset:2560
    v_lshlrev_b32 v139, 16, v139
    v_and_b32 v166, 0xffff0000, v166
    v_add_f32 v166, v139, v166
    v_lshlrev_b32 v140, 16, v140
    v_mfma_f32_32x32x16_bf16 v[64:79], a[48:51], a[52:55], v[64:79]
    ds_read_b128 a[16:19], v98 offset:18432
    ds_read_b64_tr_b16 a[20:21], v100 offset:4096
    ds_read_b64_tr_b16 a[22:23], v100 offset:4608
    v_and_b32 v168, 0xffff0000, v168
    v_add_f32 v168, v140, v168
    v_lshlrev_b32 v141, 16, v141
    v_and_b32 v170, 0xffff0000, v170
    v_mfma_f32_32x32x16_bf16 v[176:191], a[56:59], a[60:63], v[176:191]
    ds_read_b128 a[24:27], v98 offset:19456
    ds_read_b64_tr_b16 a[28:29], v100 offset:6144
    ds_read_b64_tr_b16 a[30:31], v100 offset:6656
    v_add_f32 v170, v141, v170
    v_lshlrev_b32 v142, 16, v142
    v_and_b32 v172, 0xffff0000, v172
    v_add_f32 v172, v142, v172
    s_waitcnt lgkmcnt(9)
    v_mfma_f32_32x32x16_bf16 v[64:79], a[0:3], a[4:7], v[64:79]
    ds_read_b128 a[32:35], v98 offset:20480
    ds_read_b64_tr_b16 a[36:37], v100 offset:8192
    ds_read_b64_tr_b16 a[38:39], v100 offset:8704
    ds_read_b128 a[40:43], v98 offset:21504
    ds_read_b64_tr_b16 a[44:45], v100 offset:10240
    ds_read_b64_tr_b16 a[46:47], v100 offset:10752
    v_lshlrev_b32 v143, 16, v143
    v_and_b32 v174, 0xffff0000, v174
    v_add_f32 v174, v143, v174
    v_cvt_pk_bf16_f32 v144, v144, v146
    s_waitcnt lgkmcnt(12)
    v_mfma_f32_32x32x16_bf16 v[176:191], a[8:11], a[12:15], v[176:191]
    ds_read_b128 a[48:51], v98 offset:22528
    ds_read_b64_tr_b16 a[52:53], v100 offset:12288
    ds_read_b64_tr_b16 a[54:55], v100 offset:12800
    ds_read_b128 a[56:59], v98 offset:23552
    ds_read_b64_tr_b16 a[60:61], v100 offset:14336
    ds_read_b64_tr_b16 a[62:63], v100 offset:14848
    v_and_b32 v146, 0xffff0000, v144
    v_lshlrev_b32 v144, 16, v144
    v_mul_f32 v144, v144, v145
    v_mul_f32 v146, v146, v147
    s_waitcnt lgkmcnt(15)
    v_mfma_f32_32x32x16_bf16 v[64:79], a[16:19], a[20:23], v[64:79]
    v_cvt_pk_bf16_f32 v144, v144, v146
    v_and_b32 v146, 0xffff0000, v144
    v_lshlrev_b32 v144, 16, v144
    v_mul_f32 v144, v144, v126
    s_waitcnt lgkmcnt(12)
    v_mfma_f32_32x32x16_bf16 v[176:191], a[24:27], a[28:31], v[176:191]
    v_mul_f32 v146, v146, v126
    v_cvt_pk_bf16_f32 v144, v144, v146
    v_and_b32 v146, 0xffff0000, v144
    v_lshlrev_b32 v144, 16, v144
    s_waitcnt lgkmcnt(0)
    s_barrier
    v_mfma_f32_32x32x16_bf16 v[64:79], a[32:35], a[36:39], v[64:79]
    ds_read_b128 a[0:3], v97 offset:16384
    ds_read_b64_tr_b16 a[4:5], v99 offset:16384
    ds_read_b64_tr_b16 a[6:7], v99 offset:16896
    v_cvt_pk_bf16_f32 v148, v148, v150
    v_and_b32 v150, 0xffff0000, v148
    v_lshlrev_b32 v148, 16, v148
    v_mul_f32 v148, v148, v149
    v_mfma_f32_32x32x16_bf16 v[176:191], a[40:43], a[44:47], v[176:191]
    ds_read_b128 a[8:11], v97 offset:17408
    ds_read_b64_tr_b16 a[12:13], v99 offset:18432
    ds_read_b64_tr_b16 a[14:15], v99 offset:18944
    v_mul_f32 v150, v150, v151
    v_cvt_pk_bf16_f32 v148, v148, v150
    v_and_b32 v150, 0xffff0000, v148
    v_lshlrev_b32 v148, 16, v148
    v_mfma_f32_32x32x16_bf16 v[64:79], a[48:51], a[52:55], v[64:79]
    ds_read_b128 a[16:19], v97 offset:18432
    ds_read_b64_tr_b16 a[20:21], v99 offset:20480
    ds_read_b64_tr_b16 a[22:23], v99 offset:20992
    v_mul_f32 v148, v148, v126
    v_mul_f32 v150, v150, v126
    v_cvt_pk_bf16_f32 v148, v148, v150
    v_and_b32 v150, 0xffff0000, v148
    v_mfma_f32_32x32x16_bf16 v[176:191], a[56:59], a[60:63], v[176:191]
    ds_read_b128 a[24:27], v97 offset:19456
    ds_read_b64_tr_b16 a[28:29], v99 offset:22528
    ds_read_b64_tr_b16 a[30:31], v99 offset:23040
    v_lshlrev_b32 v148, 16, v148
    v_cvt_pk_bf16_f32 v152, v152, v154
    v_and_b32 v154, 0xffff0000, v152
    v_lshlrev_b32 v152, 16, v152
    s_waitcnt lgkmcnt(9)
    v_mfma_f32_32x32x16_bf16 v[64:79], a[0:3], a[4:7], v[64:79]
    ds_read_b128 a[32:35], v97 offset:20480
    ds_read_b64_tr_b16 a[36:37], v99 offset:24576
    ds_read_b64_tr_b16 a[38:39], v99 offset:25088
    ds_read_b128 a[40:43], v97 offset:21504
    ds_read_b64_tr_b16 a[44:45], v99 offset:26624
    ds_read_b64_tr_b16 a[46:47], v99 offset:27136
    v_mul_f32 v152, v152, v153
    v_mul_f32 v154, v154, v155
    v_cvt_pk_bf16_f32 v152, v152, v154
    v_and_b32 v154, 0xffff0000, v152
    s_waitcnt lgkmcnt(12)
    v_mfma_f32_32x32x16_bf16 v[176:191], a[8:11], a[12:15], v[176:191]
    ds_read_b128 a[48:51], v97 offset:22528
    ds_read_b64_tr_b16 a[52:53], v99 offset:28672
    ds_read_b64_tr_b16 a[54:55], v99 offset:29184
    ds_read_b128 a[56:59], v97 offset:23552
    ds_read_b64_tr_b16 a[60:61], v99 offset:30720
    ds_read_b64_tr_b16 a[62:63], v99 offset:31232
    v_lshlrev_b32 v152, 16, v152
    v_mul_f32 v152, v152, v126
    v_mul_f32 v154, v154, v126
    v_cvt_pk_bf16_f32 v152, v152, v154
    s_waitcnt lgkmcnt(15)
    v_mfma_f32_32x32x16_bf16 v[64:79], a[16:19], a[20:23], v[64:79]
    v_and_b32 v154, 0xffff0000, v152
    v_lshlrev_b32 v152, 16, v152
    v_cvt_pk_bf16_f32 v156, v156, v158
    v_and_b32 v158, 0xffff0000, v156
    s_waitcnt lgkmcnt(12)
    v_mfma_f32_32x32x16_bf16 v[176:191], a[24:27], a[28:31], v[176:191]
    v_lshlrev_b32 v156, 16, v156
    v_mul_f32 v156, v156, v157
    v_mul_f32 v158, v158, v159
    v_cvt_pk_bf16_f32 v156, v156, v158
    s_waitcnt lgkmcnt(0)
    s_barrier
    v_mfma_f32_32x32x16_bf16 v[64:79], a[32:35], a[36:39], v[64:79]
    ds_read_b128 a[0:3], v98 offset:0
    ds_read_b64_tr_b16 a[4:5], v100 offset:32768
    ds_read_b64_tr_b16 a[6:7], v100 offset:33280
    v_and_b32 v158, 0xffff0000, v156
    v_lshlrev_b32 v156, 16, v156
    v_mul_f32 v156, v156, v126
    v_mul_f32 v158, v158, v126
    v_mfma_f32_32x32x16_bf16 v[176:191], a[40:43], a[44:47], v[176:191]
    ds_read_b128 a[8:11], v98 offset:1024
    ds_read_b64_tr_b16 a[12:13], v100 offset:34816
    ds_read_b64_tr_b16 a[14:15], v100 offset:35328
    v_cvt_pk_bf16_f32 v156, v156, v158
    v_and_b32 v158, 0xffff0000, v156
    v_lshlrev_b32 v156, 16, v156
    v_cvt_pk_bf16_f32 v160, v160, v162
    v_mfma_f32_32x32x16_bf16 v[64:79], a[48:51], a[52:55], v[64:79]
    ds_read_b128 a[16:19], v98 offset:2048
    ds_read_b64_tr_b16 a[20:21], v100 offset:36864
    ds_read_b64_tr_b16 a[22:23], v100 offset:37376
    v_and_b32 v162, 0xffff0000, v160
    v_lshlrev_b32 v160, 16, v160
    v_mul_f32 v160, v160, v161
    v_mul_f32 v162, v162, v163
    v_mfma_f32_32x32x16_bf16 v[176:191], a[56:59], a[60:63], v[176:191]
    ds_read_b128 a[24:27], v98 offset:3072
    ds_read_b64_tr_b16 a[28:29], v100 offset:38912
    ds_read_b64_tr_b16 a[30:31], v100 offset:39424
    v_cvt_pk_bf16_f32 v160, v160, v162
    v_and_b32 v162, 0xffff0000, v160
    v_lshlrev_b32 v160, 16, v160
    v_mul_f32 v160, v160, v126
    s_waitcnt lgkmcnt(9)
    v_mfma_f32_32x32x16_bf16 v[64:79], a[0:3], a[4:7], v[64:79]
    ds_read_b128 a[32:35], v98 offset:4096
    ds_read_b64_tr_b16 a[36:37], v100 offset:40960
    ds_read_b64_tr_b16 a[38:39], v100 offset:41472
    ds_read_b128 a[40:43], v98 offset:5120
    ds_read_b64_tr_b16 a[44:45], v100 offset:43008
    ds_read_b64_tr_b16 a[46:47], v100 offset:43520
    v_mul_f32 v162, v162, v126
    v_cvt_pk_bf16_f32 v160, v160, v162
    v_and_b32 v162, 0xffff0000, v160
    v_lshlrev_b32 v160, 16, v160
    s_waitcnt lgkmcnt(12)
    v_mfma_f32_32x32x16_bf16 v[176:191], a[8:11], a[12:15], v[176:191]
    ds_read_b128 a[48:51], v98 offset:6144
    ds_read_b64_tr_b16 a[52:53], v100 offset:45056
    ds_read_b64_tr_b16 a[54:55], v100 offset:45568
    ds_read_b128 a[56:59], v98 offset:7168
    ds_read_b64_tr_b16 a[60:61], v100 offset:47104
    ds_read_b64_tr_b16 a[62:63], v100 offset:47616
    v_cvt_pk_bf16_f32 v164, v164, v166
    v_and_b32 v166, 0xffff0000, v164
    v_lshlrev_b32 v164, 16, v164
    v_mul_f32 v164, v164, v165
    s_waitcnt lgkmcnt(15)
    v_mfma_f32_32x32x16_bf16 v[64:79], a[16:19], a[20:23], v[64:79]
    v_mul_f32 v166, v166, v167
    v_cvt_pk_bf16_f32 v164, v164, v166
    v_and_b32 v166, 0xffff0000, v164
    v_lshlrev_b32 v164, 16, v164
    s_waitcnt lgkmcnt(12)
    v_mfma_f32_32x32x16_bf16 v[176:191], a[24:27], a[28:31], v[176:191]
    v_mul_f32 v164, v164, v126
    v_mul_f32 v166, v166, v126
    v_cvt_pk_bf16_f32 v164, v164, v166
    v_and_b32 v166, 0xffff0000, v164
    s_waitcnt lgkmcnt(0)
    s_barrier
    v_mfma_f32_32x32x16_bf16 v[64:79], a[32:35], a[36:39], v[64:79]
    ds_read_b128 a[0:3], v98 offset:16384
    ds_read_b128 a[4:7], v102 offset:32768
    v_lshlrev_b32 v164, 16, v164
    v_cvt_pk_bf16_f32 v168, v168, v170
    v_and_b32 v170, 0xffff0000, v168
    v_lshlrev_b32 v168, 16, v168
    v_mfma_f32_32x32x16_bf16 v[176:191], a[40:43], a[44:47], v[176:191]
    ds_read_b128 a[8:11], v98 offset:17408
    ds_read_b128 a[12:15], v105 offset:32768
    v_mul_f32 v168, v168, v169
    v_mul_f32 v170, v170, v171
    v_cvt_pk_bf16_f32 v168, v168, v170
    v_and_b32 v170, 0xffff0000, v168
    v_mfma_f32_32x32x16_bf16 v[64:79], a[48:51], a[52:55], v[64:79]
    ds_read_b128 a[16:19], v98 offset:18432
    ds_read_b128 a[20:23], v108 offset:32768
    v_lshlrev_b32 v168, 16, v168
    v_mul_f32 v168, v168, v126
    v_mul_f32 v170, v170, v126
    v_cvt_pk_bf16_f32 v168, v168, v170
    v_mfma_f32_32x32x16_bf16 v[176:191], a[56:59], a[60:63], v[176:191]
    ds_read_b128 a[24:27], v98 offset:19456
    ds_read_b128 a[28:31], v111 offset:32768
    v_and_b32 v170, 0xffff0000, v168
    v_lshlrev_b32 v168, 16, v168
    v_cvt_pk_bf16_f32 v172, v172, v174
    v_and_b32 v174, 0xffff0000, v172
    s_waitcnt lgkmcnt(6)
    v_mfma_f32_32x32x16_bf16 v[80:95], a[0:3], a[4:7], 0
    s_nop 15
    v_add_f32 v64, v64, v176
    v_add_f32 v65, v65, v177
    v_add_f32 v66, v66, v178
    v_add_f32 v67, v67, v179
    v_add_f32 v68, v68, v180
    v_add_f32 v69, v69, v181
    v_add_f32 v70, v70, v182
    v_add_f32 v71, v71, v183
    v_add_f32 v72, v72, v184
    v_add_f32 v73, v73, v185
    v_add_f32 v74, v74, v186
    v_add_f32 v75, v75, v187
    v_add_f32 v76, v76, v188
    v_add_f32 v77, v77, v189
    v_add_f32 v78, v78, v190
    v_add_f32 v79, v79, v191
    s_nop 1
    ds_read_b128 a[32:35], v98 offset:20480
    ds_read_b128 a[36:39], v114 offset:32768
    ds_read_b128 a[40:43], v98 offset:21504
    ds_read_b128 a[44:47], v117 offset:32768
    v_lshlrev_b32 v172, 16, v172
    v_mul_f32 v172, v172, v173
    v_mul_f32 v174, v174, v175
    v_cvt_pk_bf16_f32 v172, v172, v174
    s_waitcnt lgkmcnt(8)
    v_mfma_f32_32x32x16_bf16 v[176:191], a[8:11], a[12:15], 0
    ds_read_b128 a[48:51], v98 offset:22528
    ds_read_b128 a[52:55], v120 offset:32768
    ds_read_b128 a[56:59], v98 offset:23552
    ds_read_b128 a[60:63], v123 offset:32768
    v_and_b32 v174, 0xffff0000, v172
    v_lshlrev_b32 v172, 16, v172
    v_mul_f32 v172, v172, v126
    v_mul_f32 v174, v174, v126
    s_waitcnt lgkmcnt(10)
    v_mfma_f32_32x32x16_bf16 v[80:95], a[16:19], a[20:23], v[80:95]
    v_cvt_pk_bf16_f32 v172, v172, v174
    v_and_b32 v174, 0xffff0000, v172
    v_lshlrev_b32 v172, 16, v172
    s_waitcnt lgkmcnt(8)
    v_mfma_f32_32x32x16_bf16 v[176:191], a[24:27], a[28:31], v[176:191]
    s_waitcnt lgkmcnt(0)
    s_barrier
    v_mfma_f32_32x32x16_bf16 v[80:95], a[32:35], a[36:39], v[80:95]
    ds_read_b128 a[0:3], v97 offset:0
    ds_read_b128 a[4:7], v102 offset:49152
    v_mfma_f32_32x32x16_bf16 v[176:191], a[40:43], a[44:47], v[176:191]
    ds_read_b128 a[8:11], v97 offset:1024
    ds_read_b128 a[12:15], v105 offset:49152
    v_mfma_f32_32x32x16_bf16 v[80:95], a[48:51], a[52:55], v[80:95]
    ds_read_b128 a[16:19], v97 offset:2048
    ds_read_b128 a[20:23], v108 offset:49152
    v_mfma_f32_32x32x16_bf16 v[176:191], a[56:59], a[60:63], v[176:191]
    ds_read_b128 a[24:27], v97 offset:3072
    ds_read_b128 a[28:31], v111 offset:49152
    s_waitcnt lgkmcnt(6)
    v_mfma_f32_32x32x16_bf16 v[80:95], a[0:3], a[4:7], v[80:95]
    ds_read_b128 a[32:35], v97 offset:4096
    ds_read_b128 a[36:39], v114 offset:49152
    ds_read_b128 a[40:43], v97 offset:5120
    ds_read_b128 a[44:47], v117 offset:49152
    v_cvt_pk_bf16_f32 v145, v64, v65
    v_and_b32 v65, 0xffff0000, v145
    v_lshlrev_b32 v64, 16, v145
    v_cvt_pk_bf16_f32 v149, v66, v67
    s_waitcnt lgkmcnt(8)
    v_mfma_f32_32x32x16_bf16 v[176:191], a[8:11], a[12:15], v[176:191]
    ds_read_b128 a[48:51], v97 offset:6144
    ds_read_b128 a[52:55], v120 offset:49152
    ds_read_b128 a[56:59], v97 offset:7168
    ds_read_b128 a[60:63], v123 offset:49152
    v_and_b32 v67, 0xffff0000, v149
    v_lshlrev_b32 v66, 16, v149
    v_cvt_pk_bf16_f32 v153, v68, v69
    v_and_b32 v69, 0xffff0000, v153
    s_waitcnt lgkmcnt(10)
    v_mfma_f32_32x32x16_bf16 v[80:95], a[16:19], a[20:23], v[80:95]
    v_lshlrev_b32 v68, 16, v153
    v_cvt_pk_bf16_f32 v157, v70, v71
    v_and_b32 v71, 0xffff0000, v157
    v_lshlrev_b32 v70, 16, v157
    s_waitcnt lgkmcnt(8)
    v_mfma_f32_32x32x16_bf16 v[176:191], a[24:27], a[28:31], v[176:191]
    v_cvt_pk_bf16_f32 v161, v72, v73
    v_and_b32 v73, 0xffff0000, v161
    v_lshlrev_b32 v72, 16, v161
    v_cvt_pk_bf16_f32 v165, v74, v75
    s_waitcnt lgkmcnt(0)
    s_barrier
    v_mfma_f32_32x32x16_bf16 v[80:95], a[32:35], a[36:39], v[80:95]
    ds_read_b128 a[0:3], v96 offset:0
    ds_read_b128 a[4:7], v103 offset:49152
    v_and_b32 v75, 0xffff0000, v165
    v_lshlrev_b32 v74, 16, v165
    v_cvt_pk_bf16_f32 v169, v76, v77
    v_and_b32 v77, 0xffff0000, v169
    v_mfma_f32_32x32x16_bf16 v[176:191], a[40:43], a[44:47], v[176:191]
    ds_read_b128 a[8:11], v96 offset:1024
    ds_read_b128 a[12:15], v106 offset:49152
    v_lshlrev_b32 v76, 16, v169
    v_cvt_pk_bf16_f32 v173, v78, v79
    v_and_b32 v79, 0xffff0000, v173
    v_lshlrev_b32 v78, 16, v173
    v_mfma_f32_32x32x16_bf16 v[80:95], a[48:51], a[52:55], v[80:95]
    ds_read_b128 a[16:19], v96 offset:2048
    ds_read_b128 a[20:23], v109 offset:49152
    v_mul_f32 v145, -1.4426950408889634, v64
    v_mul_f32 v147, -1.4426950408889634, v65
    v_mul_f32 v149, -1.4426950408889634, v66
    v_mul_f32 v151, -1.4426950408889634, v67
    v_mfma_f32_32x32x16_bf16 v[176:191], a[56:59], a[60:63], v[176:191]
    ds_read_b128 a[24:27], v96 offset:3072
    ds_read_b128 a[28:31], v112 offset:49152
    v_mul_f32 v153, -1.4426950408889634, v68
    v_mul_f32 v155, -1.4426950408889634, v69
    v_mul_f32 v157, -1.4426950408889634, v70
    v_mul_f32 v159, -1.4426950408889634, v71
    s_waitcnt lgkmcnt(6)
    v_mfma_f32_32x32x16_bf16 v[80:95], a[0:3], a[4:7], v[80:95]
    ds_read_b128 a[32:35], v96 offset:4096
    ds_read_b128 a[36:39], v115 offset:49152
    ds_read_b128 a[40:43], v96 offset:5120
    ds_read_b128 a[44:47], v118 offset:49152
    v_mul_f32 v161, -1.4426950408889634, v72
    v_mul_f32 v163, -1.4426950408889634, v73
    v_mul_f32 v165, -1.4426950408889634, v74
    v_mul_f32 v167, -1.4426950408889634, v75
    s_waitcnt lgkmcnt(8)
    v_mfma_f32_32x32x16_bf16 v[176:191], a[8:11], a[12:15], v[176:191]
    ds_read_b128 a[48:51], v96 offset:6144
    ds_read_b128 a[52:55], v121 offset:49152
    ds_read_b128 a[56:59], v96 offset:7168
    ds_read_b128 a[60:63], v124 offset:49152
    v_mul_f32 v169, -1.4426950408889634, v76
    v_mul_f32 v171, -1.4426950408889634, v77
    v_mul_f32 v173, -1.4426950408889634, v78
    v_mul_f32 v175, -1.4426950408889634, v79
    s_waitcnt lgkmcnt(10)
    v_mfma_f32_32x32x16_bf16 v[80:95], a[16:19], a[20:23], v[80:95]
    v_exp_f32 v145, v145
    v_exp_f32 v147, v147
    v_exp_f32 v149, v149
    v_exp_f32 v151, v151
    s_waitcnt lgkmcnt(8)
    v_mfma_f32_32x32x16_bf16 v[176:191], a[24:27], a[28:31], v[176:191]
    v_exp_f32 v153, v153
    v_exp_f32 v155, v155
    v_exp_f32 v157, v157
    v_exp_f32 v159, v159
    s_waitcnt lgkmcnt(0)
    s_barrier
    v_mfma_f32_32x32x16_bf16 v[80:95], a[32:35], a[36:39], v[80:95]
    ds_read_b128 a[0:3], v97 offset:16384
    ds_read_b128 a[4:7], v102 offset:16384
    v_exp_f32 v161, v161
    v_exp_f32 v163, v163
    v_exp_f32 v165, v165
    v_exp_f32 v167, v167
    v_mfma_f32_32x32x16_bf16 v[176:191], a[40:43], a[44:47], v[176:191]
    ds_read_b128 a[8:11], v97 offset:17408
    ds_read_b128 a[12:15], v105 offset:16384
    v_exp_f32 v169, v169
    v_exp_f32 v171, v171
    v_exp_f32 v173, v173
    v_exp_f32 v175, v175
    v_mfma_f32_32x32x16_bf16 v[80:95], a[48:51], a[52:55], v[80:95]
    ds_read_b128 a[16:19], v97 offset:18432
    ds_read_b128 a[20:23], v108 offset:16384
    v_add_f32 v145, 1.0, v145
    v_add_f32 v147, 1.0, v147
    v_add_f32 v149, 1.0, v149
    v_add_f32 v151, 1.0, v151
    v_mfma_f32_32x32x16_bf16 v[176:191], a[56:59], a[60:63], v[176:191]
    ds_read_b128 a[24:27], v97 offset:19456
    ds_read_b128 a[28:31], v111 offset:16384
    v_add_f32 v153, 1.0, v153
    v_add_f32 v155, 1.0, v155
    v_add_f32 v157, 1.0, v157
    v_add_f32 v159, 1.0, v159
    s_waitcnt lgkmcnt(6)
    v_mfma_f32_32x32x16_bf16 v[80:95], a[0:3], a[4:7], v[80:95]
    ds_read_b128 a[32:35], v97 offset:20480
    ds_read_b128 a[36:39], v114 offset:16384
    ds_read_b128 a[40:43], v97 offset:21504
    ds_read_b128 a[44:47], v117 offset:16384
    v_add_f32 v161, 1.0, v161
    v_add_f32 v163, 1.0, v163
    v_add_f32 v165, 1.0, v165
    v_add_f32 v167, 1.0, v167
    s_waitcnt lgkmcnt(8)
    v_mfma_f32_32x32x16_bf16 v[176:191], a[8:11], a[12:15], v[176:191]
    ds_read_b128 a[48:51], v97 offset:22528
    ds_read_b128 a[52:55], v120 offset:16384
    ds_read_b128 a[56:59], v97 offset:23552
    ds_read_b128 a[60:63], v123 offset:16384
    v_add_f32 v169, 1.0, v169
    v_add_f32 v171, 1.0, v171
    v_add_f32 v173, 1.0, v173
    v_add_f32 v175, 1.0, v175
    s_waitcnt lgkmcnt(10)
    v_mfma_f32_32x32x16_bf16 v[80:95], a[16:19], a[20:23], v[80:95]
    v_rcp_f32 v145, v145
    v_rcp_f32 v147, v147
    v_rcp_f32 v149, v149
    v_rcp_f32 v151, v151
    s_waitcnt lgkmcnt(8)
    v_mfma_f32_32x32x16_bf16 v[176:191], a[24:27], a[28:31], v[176:191]
    v_rcp_f32 v153, v153
    v_rcp_f32 v155, v155
    v_rcp_f32 v157, v157
    v_rcp_f32 v159, v159
    s_waitcnt lgkmcnt(0)
    s_barrier
    v_mfma_f32_32x32x16_bf16 v[80:95], a[32:35], a[36:39], v[80:95]
    ds_read_b128 a[0:3], v98 offset:0
    ds_read_b128 a[4:7], v103 offset:32768
    v_rcp_f32 v161, v161
    v_rcp_f32 v163, v163
    v_rcp_f32 v165, v165
    v_rcp_f32 v167, v167
    v_mfma_f32_32x32x16_bf16 v[176:191], a[40:43], a[44:47], v[176:191]
    ds_read_b128 a[8:11], v98 offset:1024
    ds_read_b128 a[12:15], v106 offset:32768
    v_rcp_f32 v169, v169
    v_rcp_f32 v171, v171
    v_rcp_f32 v173, v173
    v_rcp_f32 v175, v175
    v_mfma_f32_32x32x16_bf16 v[80:95], a[48:51], a[52:55], v[80:95]
    ds_read_b128 a[16:19], v98 offset:2048
    ds_read_b128 a[20:23], v109 offset:32768
    v_mul_f32 v64, v64, v145
    v_mul_f32 v65, v65, v147
    v_mul_f32 v66, v66, v149
    v_mul_f32 v67, v67, v151
    v_mfma_f32_32x32x16_bf16 v[176:191], a[56:59], a[60:63], v[176:191]
    ds_read_b128 a[24:27], v98 offset:3072
    ds_read_b128 a[28:31], v112 offset:32768
    v_mul_f32 v68, v68, v153
    v_mul_f32 v69, v69, v155
    v_mul_f32 v70, v70, v157
    v_mul_f32 v71, v71, v159
    s_waitcnt lgkmcnt(6)
    v_mfma_f32_32x32x16_bf16 v[80:95], a[0:3], a[4:7], v[80:95]
    ds_read_b128 a[32:35], v98 offset:4096
    ds_read_b128 a[36:39], v115 offset:32768
    ds_read_b128 a[40:43], v98 offset:5120
    ds_read_b128 a[44:47], v118 offset:32768
    v_mul_f32 v72, v72, v161
    v_mul_f32 v73, v73, v163
    v_mul_f32 v74, v74, v165
    v_mul_f32 v75, v75, v167
    s_waitcnt lgkmcnt(8)
    v_mfma_f32_32x32x16_bf16 v[176:191], a[8:11], a[12:15], v[176:191]
    ds_read_b128 a[48:51], v98 offset:6144
    ds_read_b128 a[52:55], v121 offset:32768
    ds_read_b128 a[56:59], v98 offset:7168
    ds_read_b128 a[60:63], v124 offset:32768
    v_mul_f32 v76, v76, v169
    v_mul_f32 v77, v77, v171
    v_mul_f32 v78, v78, v173
    v_mul_f32 v79, v79, v175
    s_waitcnt lgkmcnt(10)
    v_mfma_f32_32x32x16_bf16 v[80:95], a[16:19], a[20:23], v[80:95]
    v_cvt_pk_bf16_f32 v145, v64, v65
    v_and_b32 v65, 0xffff0000, v145
    v_lshlrev_b32 v64, 16, v145
    v_cvt_pk_bf16_f32 v149, v66, v67
    s_waitcnt lgkmcnt(8)
    v_mfma_f32_32x32x16_bf16 v[176:191], a[24:27], a[28:31], v[176:191]
    v_and_b32 v67, 0xffff0000, v149
    v_lshlrev_b32 v66, 16, v149
    v_cvt_pk_bf16_f32 v153, v68, v69
    v_and_b32 v69, 0xffff0000, v153
    s_waitcnt lgkmcnt(0)
    s_barrier
    v_mfma_f32_32x32x16_bf16 v[80:95], a[32:35], a[36:39], v[80:95]
    ds_read_b128 a[0:3], v98 offset:16384
    ds_read_b128 a[4:7], v102 offset:32768
    v_lshlrev_b32 v68, 16, v153
    v_cvt_pk_bf16_f32 v157, v70, v71
    v_and_b32 v71, 0xffff0000, v157
    v_lshlrev_b32 v70, 16, v157
    v_mfma_f32_32x32x16_bf16 v[176:191], a[40:43], a[44:47], v[176:191]
    ds_read_b128 a[8:11], v98 offset:17408
    ds_read_b128 a[12:15], v105 offset:32768
    v_cvt_pk_bf16_f32 v161, v72, v73
    v_and_b32 v73, 0xffff0000, v161
    v_lshlrev_b32 v72, 16, v161
    v_cvt_pk_bf16_f32 v165, v74, v75
    v_mfma_f32_32x32x16_bf16 v[80:95], a[48:51], a[52:55], v[80:95]
    ds_read_b128 a[16:19], v98 offset:18432
    ds_read_b128 a[20:23], v108 offset:32768
    v_and_b32 v75, 0xffff0000, v165
    v_lshlrev_b32 v74, 16, v165
    v_cvt_pk_bf16_f32 v169, v76, v77
    v_and_b32 v77, 0xffff0000, v169
    v_mfma_f32_32x32x16_bf16 v[176:191], a[56:59], a[60:63], v[176:191]
    ds_read_b128 a[24:27], v98 offset:19456
    ds_read_b128 a[28:31], v111 offset:32768
    v_lshlrev_b32 v76, 16, v169
    v_cvt_pk_bf16_f32 v173, v78, v79
    v_and_b32 v79, 0xffff0000, v173
    v_lshlrev_b32 v78, 16, v173
    s_waitcnt lgkmcnt(6)
    v_mfma_f32_32x32x16_bf16 v[80:95], a[0:3], a[4:7], v[80:95]
    ds_read_b128 a[32:35], v98 offset:20480
    ds_read_b128 a[36:39], v114 offset:32768
    ds_read_b128 a[40:43], v98 offset:21504
    ds_read_b128 a[44:47], v117 offset:32768
    s_waitcnt lgkmcnt(8)
    v_mfma_f32_32x32x16_bf16 v[176:191], a[8:11], a[12:15], v[176:191]
    ds_read_b128 a[48:51], v98 offset:22528
    ds_read_b128 a[52:55], v120 offset:32768
    ds_read_b128 a[56:59], v98 offset:23552
    ds_read_b128 a[60:63], v123 offset:32768
    s_waitcnt lgkmcnt(10)
    v_mfma_f32_32x32x16_bf16 v[80:95], a[16:19], a[20:23], v[80:95]
    s_waitcnt lgkmcnt(8)
    v_mfma_f32_32x32x16_bf16 v[176:191], a[24:27], a[28:31], v[176:191]
    s_waitcnt lgkmcnt(0)
    s_barrier
    v_mfma_f32_32x32x16_bf16 v[80:95], a[32:35], a[36:39], v[80:95]
    ds_read_b128 a[0:3], v97 offset:0
    ds_read_b128 a[4:7], v102 offset:49152
    v_mfma_f32_32x32x16_bf16 v[176:191], a[40:43], a[44:47], v[176:191]
    ds_read_b128 a[8:11], v97 offset:1024
    ds_read_b128 a[12:15], v105 offset:49152
    v_mfma_f32_32x32x16_bf16 v[80:95], a[48:51], a[52:55], v[80:95]
    ds_read_b128 a[16:19], v97 offset:2048
    ds_read_b128 a[20:23], v108 offset:49152
    v_mfma_f32_32x32x16_bf16 v[176:191], a[56:59], a[60:63], v[176:191]
    ds_read_b128 a[24:27], v97 offset:3072
    ds_read_b128 a[28:31], v111 offset:49152
    s_waitcnt lgkmcnt(6)
    v_mfma_f32_32x32x16_bf16 v[80:95], a[0:3], a[4:7], v[80:95]
    ds_read_b128 a[32:35], v97 offset:4096
    ds_read_b128 a[36:39], v114 offset:49152
    ds_read_b128 a[40:43], v97 offset:5120
    ds_read_b128 a[44:47], v117 offset:49152
    s_waitcnt lgkmcnt(8)
    v_mfma_f32_32x32x16_bf16 v[176:191], a[8:11], a[12:15], v[176:191]
    ds_read_b128 a[48:51], v97 offset:6144
    ds_read_b128 a[52:55], v120 offset:49152
    ds_read_b128 a[56:59], v97 offset:7168
    ds_read_b128 a[60:63], v123 offset:49152
    s_waitcnt lgkmcnt(10)
    v_mfma_f32_32x32x16_bf16 v[80:95], a[16:19], a[20:23], v[80:95]
    s_waitcnt lgkmcnt(8)
    v_mfma_f32_32x32x16_bf16 v[176:191], a[24:27], a[28:31], v[176:191]
    s_waitcnt lgkmcnt(6)
    v_mfma_f32_32x32x16_bf16 v[80:95], a[32:35], a[36:39], v[80:95]
    s_waitcnt lgkmcnt(4)
    v_mfma_f32_32x32x16_bf16 v[176:191], a[40:43], a[44:47], v[176:191]
    s_waitcnt lgkmcnt(2)
    v_mfma_f32_32x32x16_bf16 v[80:95], a[48:51], a[52:55], v[80:95]
    s_waitcnt lgkmcnt(0)
    v_mfma_f32_32x32x16_bf16 v[176:191], a[56:59], a[60:63], v[176:191]
    s_nop 15
    v_add_f32 v80, v80, v144
    v_add_f32 v81, v81, v146
    v_add_f32 v82, v82, v148
    v_add_f32 v83, v83, v150
    v_add_f32 v84, v84, v152
    v_add_f32 v85, v85, v154
    v_add_f32 v86, v86, v156
    v_add_f32 v87, v87, v158
    v_add_f32 v88, v88, v160
    v_add_f32 v89, v89, v162
    v_add_f32 v90, v90, v164
    v_add_f32 v91, v91, v166
    v_add_f32 v92, v92, v168
    v_add_f32 v93, v93, v170
    v_add_f32 v94, v94, v172
    v_add_f32 v95, v95, v174
    v_add_f32 v80, v80, v176
    v_add_f32 v81, v81, v177
    v_add_f32 v82, v82, v178
    v_add_f32 v83, v83, v179
    v_add_f32 v84, v84, v180
    v_add_f32 v85, v85, v181
    v_add_f32 v86, v86, v182
    v_add_f32 v87, v87, v183
    v_add_f32 v88, v88, v184
    v_add_f32 v89, v89, v185
    v_add_f32 v90, v90, v186
    v_add_f32 v91, v91, v187
    v_add_f32 v92, v92, v188
    v_add_f32 v93, v93, v189
    v_add_f32 v94, v94, v190
    v_add_f32 v95, v95, v191
    v_fma_f32 v128, v80, v64, v128
    v_fma_f32 v129, v81, v65, v129
    v_fma_f32 v130, v82, v66, v130
    v_fma_f32 v131, v83, v67, v131
    v_fma_f32 v132, v84, v68, v132
    v_fma_f32 v133, v85, v69, v133
    v_fma_f32 v134, v86, v70, v134
    v_fma_f32 v135, v87, v71, v135
    v_fma_f32 v136, v88, v72, v136
    v_fma_f32 v137, v89, v73, v137
    v_fma_f32 v138, v90, v74, v138
    v_fma_f32 v139, v91, v75, v139
    v_fma_f32 v140, v92, v76, v140
    v_fma_f32 v141, v93, v77, v141
    v_fma_f32 v142, v94, v78, v142
    v_fma_f32 v143, v95, v79, v143
    buffer_store_dword v128, v127, s[52:55], s68 offen offset:0
    buffer_store_dword v129, v127, s[52:55], s68 offen offset:1792
    s_add_u32 s68, s68, 3584
    buffer_store_dword v130, v127, s[52:55], s68 offen offset:0
    buffer_store_dword v131, v127, s[52:55], s68 offen offset:1792
    s_add_u32 s68, s68, 3584
    buffer_store_dword v132, v127, s[52:55], s68 offen offset:0
    buffer_store_dword v133, v127, s[52:55], s68 offen offset:1792
    s_add_u32 s68, s68, 3584
    buffer_store_dword v134, v127, s[52:55], s68 offen offset:0
    buffer_store_dword v135, v127, s[52:55], s68 offen offset:1792
    s_add_u32 s68, s68, 3584
    buffer_store_dword v136, v127, s[52:55], s68 offen offset:0
    buffer_store_dword v137, v127, s[52:55], s68 offen offset:1792
    s_add_u32 s68, s68, 3584
    buffer_store_dword v138, v127, s[52:55], s68 offen offset:0
    buffer_store_dword v139, v127, s[52:55], s68 offen offset:1792
    s_add_u32 s68, s68, 3584
    buffer_store_dword v140, v127, s[52:55], s68 offen offset:0
    buffer_store_dword v141, v127, s[52:55], s68 offen offset:1792
    s_add_u32 s68, s68, 3584
    buffer_store_dword v142, v127, s[52:55], s68 offen offset:0
    buffer_store_dword v143, v127, s[52:55], s68 offen offset:1792
    s_branch L_END
L_HELPER:
    s_sub_u32 s72, s5, 28
    s_lshr_b32 s77, s4, 1
    s_and_b32 s78, s4, 1
    s_lshl_b32 s73, s77, 3
    s_lshl_b32 s79, s78, 2
    s_add_u32 s73, s73, s79
    s_add_u32 s73, s73, s72
    s_lshl_b32 s74, s77, 2
    s_add_u32 s74, s74, s72
    s_mul_i32 s75, s78, 7
    s_lshr_b32 s79, s74, 1
    s_add_u32 s75, s75, s79
    s_and_b32 s76, s74, 1
    s_min_u32 s75, s75, 13
    s_lshl_b32 s79, s10, 3
    v_add_u32 v5, s79, v3
    v_mul_u32_u24 v5, 896, v5
    v_lshl_add_u32 v5, v4, 4, v5
    s_mul_i32 s68, s73, 57344
    s_lshl_b32 s79, s11, 3
    v_add_u32 v7, s79, v3
    v_mul_u32_u24 v7, 896, v7
    v_lshl_add_u32 v7, v4, 4, v7
    s_mul_i32 s70, s75, 28672
    s_mul_i32 s79, s11, 56
    v_add_u32 v8, s79, v3
    v_mul_u32_u24 v8, 3584, v8
    v_lshl_add_u32 v8, v4, 4, v8
    s_mul_i32 s69, s76, 802816
    s_lshl_b32 s79, s75, 8
    s_add_u32 s69, s69, s79
    v_mov_b32 v12, 0
    s_waitcnt lgkmcnt(0)
    s_cmp_lg_u32 s2, 224
    s_cbranch_scc1 NOTAG_20
    s_cmp_lg_u32 s10, 0
    s_cbranch_scc1 NOTAG_20
    s_memrealtime s[90:91]
    s_waitcnt lgkmcnt(0)
    s_or_b32 s91, s91, 0x80000000
    v_mov_b32 v10, s90
    v_mov_b32 v11, s91
    s_mov_b64 exec, 1
    buffer_store_dwordx2 v[10:11], v12, s[56:59], 0 offen sc1
    s_mov_b64 exec, -1
NOTAG_20:
    buffer_load_dwordx4 v[32:35], v5, s[16:19], s68 offen offset:0
    buffer_load_dwordx4 v[36:39], v5, s[16:19], s68 offen offset:128
    buffer_load_dwordx4 v[40:43], v5, s[16:19], s68 offen offset:256
    buffer_load_dwordx4 v[44:47], v5, s[16:19], s68 offen offset:384
    buffer_load_dwordx4 v[48:51], v5, s[16:19], s68 offen offset:512
    buffer_load_dwordx4 v[52:55], v5, s[16:19], s68 offen offset:640
    buffer_load_dwordx4 v[56:59], v5, s[16:19], s68 offen offset:768
    buffer_load_dwordx2 v[10:11], v12, s[56:59], 0 offen sc1
    s_cmp_eq_u32 s76, 0
    s_cselect_b32 s92, s28, s32
    s_cselect_b32 s93, s29, s33
    s_mov_b32 s94, 401408
    s_mov_b32 s95, 0x20000
    buffer_load_dwordx4 v[60:63], v7, s[92:95], s70 offen offset:0
    buffer_load_dwordx4 v[64:67], v7, s[92:95], s70 offen offset:128
    buffer_load_dwordx4 v[68:71], v7, s[92:95], s70 offen offset:256
    buffer_load_dwordx4 v[72:75], v7, s[92:95], s70 offen offset:384
    buffer_load_dwordx4 v[76:79], v7, s[92:95], s70 offen offset:512
    buffer_load_dwordx4 v[80:83], v7, s[92:95], s70 offen offset:640
    buffer_load_dwordx4 v[84:87], v7, s[92:95], s70 offen offset:768
    s_cmp_eq_u32 s12, 0
    s_cselect_b32 s52, s20, s24
    s_cselect_b32 s53, s21, s25
    s_mov_b32 s54, 1605632
    s_mov_b32 s55, 0x20000
    s_add_u32 s79, s69, 0
    buffer_load_dwordx4 v[88:91], v8, s[52:55], s79 offen offset:0
    s_add_u32 s79, s69, 28672
    buffer_load_dwordx4 v[92:95], v8, s[52:55], s79 offen offset:0
    s_add_u32 s79, s69, 57344
    buffer_load_dwordx4 v[96:99], v8, s[52:55], s79 offen offset:0
    s_add_u32 s79, s69, 86016
    buffer_load_dwordx4 v[100:103], v8, s[52:55], s79 offen offset:0
    s_add_u32 s79, s69, 114688
    buffer_load_dwordx4 v[104:107], v8, s[52:55], s79 offen offset:0
    s_add_u32 s79, s69, 143360
    buffer_load_dwordx4 v[108:111], v8, s[52:55], s79 offen offset:0
    s_add_u32 s79, s69, 172032
    buffer_load_dwordx4 v[112:115], v8, s[52:55], s79 offen offset:0
    s_add_u32 s79, s69, 0
    buffer_load_dwordx4 a[0:3], v8, s[52:55], s79 offen offset:128
    s_add_u32 s79, s69, 28672
    buffer_load_dwordx4 a[4:7], v8, s[52:55], s79 offen offset:128
    s_add_u32 s79, s69, 57344
    buffer_load_dwordx4 a[8:11], v8, s[52:55], s79 offen offset:128
    s_add_u32 s79, s69, 86016
    buffer_load_dwordx4 a[12:15], v8, s[52:55], s79 offen offset:128
    s_add_u32 s79, s69, 114688
    buffer_load_dwordx4 a[16:19], v8, s[52:55], s79 offen offset:128
    s_add_u32 s79, s69, 143360
    buffer_load_dwordx4 a[20:23], v8, s[52:55], s79 offen offset:128
    s_add_u32 s79, s69, 172032
    buffer_load_dwordx4 a[24:27], v8, s[52:55], s79 offen offset:128
    v_mov_b32 v13, 0x3f803f80
    v_mov_b32 v14, 0x00003f80
    v_mov_b32 v15, 0x3f800000
    s_waitcnt vmcnt(22)
    v_mov_b32 v16, 0
    v_mov_b32 v17, 0
    v_mov_b32 v18, 0
    v_mov_b32 v19, 0
    v_dot2_f32_bf16 v16, v32, v13, v16
    v_dot2_f32_bf16 v17, v33, v13, v17
    v_dot2_f32_bf16 v18, v34, v13, v18
    v_dot2_f32_bf16 v19, v35, v13, v19
    v_dot2_f32_bf16 v16, v36, v13, v16
    v_dot2_f32_bf16 v17, v37, v13, v17
    v_dot2_f32_bf16 v18, v38, v13, v18
    v_dot2_f32_bf16 v19, v39, v13, v19
    v_dot2_f32_bf16 v16, v40, v13, v16
    v_dot2_f32_bf16 v17, v41, v13, v17
    v_dot2_f32_bf16 v18, v42, v13, v18
    v_dot2_f32_bf16 v19, v43, v13, v19
    v_dot2_f32_bf16 v16, v44, v13, v16
    v_dot2_f32_bf16 v17, v45, v13, v17
    v_dot2_f32_bf16 v18, v46, v13, v18
    v_dot2_f32_bf16 v19, v47, v13, v19
    v_dot2_f32_bf16 v16, v48, v13, v16
    v_dot2_f32_bf16 v17, v49, v13, v17
    v_dot2_f32_bf16 v18, v50, v13, v18
    v_dot2_f32_bf16 v19, v51, v13, v19
    v_dot2_f32_bf16 v16, v52, v13, v16
    v_dot2_f32_bf16 v17, v53, v13, v17
    v_dot2_f32_bf16 v18, v54, v13, v18
    v_dot2_f32_bf16 v19, v55, v13, v19
    v_dot2_f32_bf16 v16, v56, v13, v16
    v_dot2_f32_bf16 v17, v57, v13, v17
    v_dot2_f32_bf16 v18, v58, v13, v18
    v_dot2_f32_bf16 v19, v59, v13, v19
    s_nop 2
    v_add_f32 v16, v16, v17
    v_add_f32 v18, v18, v19
    v_add_f32 v16, v16, v18
    s_nop 1
    v_add_f32_dpp v16, v16, v16 quad_perm:[1,0,3,2] row_mask:0xf bank_mask:0xf
    s_nop 1
    v_add_f32_dpp v16, v16, v16 quad_perm:[2,3,0,1] row_mask:0xf bank_mask:0xf
    s_nop 1
    v_add_f32_dpp v16, v16, v16 row_half_mirror row_mask:0xf bank_mask:0xf
    v_mul_f32 v16, -0.002232142857142857, v16
    v_mov_b32 v17, v16
    v_mov_b32 v18, 0
    v_mov_b32 v19, 0
    v_mov_b32 v20, 0
    v_mov_b32 v21, 0
    v_lshlrev_b32 v22, 16, v32
    v_and_b32 v23, 0xffff0000, v32
    v_pk_add_f32 v[22:23], v[22:23], v[16:17]
    v_pk_fma_f32 v[18:19], v[22:23], v[22:23], v[18:19]
    v_lshlrev_b32 v24, 16, v33
    v_and_b32 v25, 0xffff0000, v33
    v_pk_add_f32 v[24:25], v[24:25], v[16:17]
    v_pk_fma_f32 v[20:21], v[24:25], v[24:25], v[20:21]
    v_lshlrev_b32 v26, 16, v34
    v_and_b32 v27, 0xffff0000, v34
    v_pk_add_f32 v[26:27], v[26:27], v[16:17]
    v_pk_fma_f32 v[18:19], v[26:27], v[26:27], v[18:19]
    v_lshlrev_b32 v28, 16, v35
    v_and_b32 v29, 0xffff0000, v35
    v_pk_add_f32 v[28:29], v[28:29], v[16:17]
    v_pk_fma_f32 v[20:21], v[28:29], v[28:29], v[20:21]
    v_lshlrev_b32 v22, 16, v36
    v_and_b32 v23, 0xffff0000, v36
    v_pk_add_f32 v[22:23], v[22:23], v[16:17]
    v_pk_fma_f32 v[18:19], v[22:23], v[22:23], v[18:19]
    v_lshlrev_b32 v24, 16, v37
    v_and_b32 v25, 0xffff0000, v37
    v_pk_add_f32 v[24:25], v[24:25], v[16:17]
    v_pk_fma_f32 v[20:21], v[24:25], v[24:25], v[20:21]
    v_lshlrev_b32 v26, 16, v38
    v_and_b32 v27, 0xffff0000, v38
    v_pk_add_f32 v[26:27], v[26:27], v[16:17]
    v_pk_fma_f32 v[18:19], v[26:27], v[26:27], v[18:19]
    v_lshlrev_b32 v28, 16, v39
    v_and_b32 v29, 0xffff0000, v39
    v_pk_add_f32 v[28:29], v[28:29], v[16:17]
    v_pk_fma_f32 v[20:21], v[28:29], v[28:29], v[20:21]
    v_lshlrev_b32 v22, 16, v40
    v_and_b32 v23, 0xffff0000, v40
    v_pk_add_f32 v[22:23], v[22:23], v[16:17]
    v_pk_fma_f32 v[18:19], v[22:23], v[22:23], v[18:19]
    v_lshlrev_b32 v24, 16, v41
    v_and_b32 v25, 0xffff0000, v41
    v_pk_add_f32 v[24:25], v[24:25], v[16:17]
    v_pk_fma_f32 v[20:21], v[24:25], v[24:25], v[20:21]
    v_lshlrev_b32 v26, 16, v42
    v_and_b32 v27, 0xffff0000, v42
    v_pk_add_f32 v[26:27], v[26:27], v[16:17]
    v_pk_fma_f32 v[18:19], v[26:27], v[26:27], v[18:19]
    v_lshlrev_b32 v28, 16, v43
    v_and_b32 v29, 0xffff0000, v43
    v_pk_add_f32 v[28:29], v[28:29], v[16:17]
    v_pk_fma_f32 v[20:21], v[28:29], v[28:29], v[20:21]
    v_lshlrev_b32 v22, 16, v44
    v_and_b32 v23, 0xffff0000, v44
    v_pk_add_f32 v[22:23], v[22:23], v[16:17]
    v_pk_fma_f32 v[18:19], v[22:23], v[22:23], v[18:19]
    v_lshlrev_b32 v24, 16, v45
    v_and_b32 v25, 0xffff0000, v45
    v_pk_add_f32 v[24:25], v[24:25], v[16:17]
    v_pk_fma_f32 v[20:21], v[24:25], v[24:25], v[20:21]
    v_lshlrev_b32 v26, 16, v46
    v_and_b32 v27, 0xffff0000, v46
    v_pk_add_f32 v[26:27], v[26:27], v[16:17]
    v_pk_fma_f32 v[18:19], v[26:27], v[26:27], v[18:19]
    v_lshlrev_b32 v28, 16, v47
    v_and_b32 v29, 0xffff0000, v47
    v_pk_add_f32 v[28:29], v[28:29], v[16:17]
    v_pk_fma_f32 v[20:21], v[28:29], v[28:29], v[20:21]
    v_lshlrev_b32 v22, 16, v48
    v_and_b32 v23, 0xffff0000, v48
    v_pk_add_f32 v[22:23], v[22:23], v[16:17]
    v_pk_fma_f32 v[18:19], v[22:23], v[22:23], v[18:19]
    v_lshlrev_b32 v24, 16, v49
    v_and_b32 v25, 0xffff0000, v49
    v_pk_add_f32 v[24:25], v[24:25], v[16:17]
    v_pk_fma_f32 v[20:21], v[24:25], v[24:25], v[20:21]
    v_lshlrev_b32 v26, 16, v50
    v_and_b32 v27, 0xffff0000, v50
    v_pk_add_f32 v[26:27], v[26:27], v[16:17]
    v_pk_fma_f32 v[18:19], v[26:27], v[26:27], v[18:19]
    v_lshlrev_b32 v28, 16, v51
    v_and_b32 v29, 0xffff0000, v51
    v_pk_add_f32 v[28:29], v[28:29], v[16:17]
    v_pk_fma_f32 v[20:21], v[28:29], v[28:29], v[20:21]
    v_lshlrev_b32 v22, 16, v52
    v_and_b32 v23, 0xffff0000, v52
    v_pk_add_f32 v[22:23], v[22:23], v[16:17]
    v_pk_fma_f32 v[18:19], v[22:23], v[22:23], v[18:19]
    v_lshlrev_b32 v24, 16, v53
    v_and_b32 v25, 0xffff0000, v53
    v_pk_add_f32 v[24:25], v[24:25], v[16:17]
    v_pk_fma_f32 v[20:21], v[24:25], v[24:25], v[20:21]
    v_lshlrev_b32 v26, 16, v54
    v_and_b32 v27, 0xffff0000, v54
    v_pk_add_f32 v[26:27], v[26:27], v[16:17]
    v_pk_fma_f32 v[18:19], v[26:27], v[26:27], v[18:19]
    v_lshlrev_b32 v28, 16, v55
    v_and_b32 v29, 0xffff0000, v55
    v_pk_add_f32 v[28:29], v[28:29], v[16:17]
    v_pk_fma_f32 v[20:21], v[28:29], v[28:29], v[20:21]
    v_lshlrev_b32 v22, 16, v56
    v_and_b32 v23, 0xffff0000, v56
    v_pk_add_f32 v[22:23], v[22:23], v[16:17]
    v_pk_fma_f32 v[18:19], v[22:23], v[22:23], v[18:19]
    v_lshlrev_b32 v24, 16, v57
    v_and_b32 v25, 0xffff0000, v57
    v_pk_add_f32 v[24:25], v[24:25], v[16:17]
    v_pk_fma_f32 v[20:21], v[24:25], v[24:25], v[20:21]
    v_lshlrev_b32 v26, 16, v58
    v_and_b32 v27, 0xffff0000, v58
    v_pk_add_f32 v[26:27], v[26:27], v[16:17]
    v_pk_fma_f32 v[18:19], v[26:27], v[26:27], v[18:19]
    v_lshlrev_b32 v28, 16, v59
    v_and_b32 v29, 0xffff0000, v59
    v_pk_add_f32 v[28:29], v[28:29], v[16:17]
    v_pk_fma_f32 v[20:21], v[28:29], v[28:29], v[20:21]
    v_add_f32 v18, v18, v19
    v_add_f32 v20, v20, v21
    v_add_f32 v18, v18, v20
    s_nop 1
    v_add_f32_dpp v18, v18, v18 quad_perm:[1,0,3,2] row_mask:0xf bank_mask:0xf
    s_nop 1
    v_add_f32_dpp v18, v18, v18 quad_perm:[2,3,0,1] row_mask:0xf bank_mask:0xf
    s_nop 1
    v_add_f32_dpp v18, v18, v18 row_half_mirror row_mask:0xf bank_mask:0xf
    v_mul_f32 v18, 0.002232142857142857, v18
    v_cvt_pk_bf16_f32 v116, v16, v16
    v_cvt_pk_bf16_f32 v18, v18, v18
    v_and_b32 v18, 0xffff0000, v18
    v_add_f32 v18, 1e-05, v18
    v_cvt_pk_bf16_f32 v18, v18, v18
    v_and_b32 v18, 0xffff0000, v18
    v_sqrt_f32 v18, v18
    s_nop 0
    v_cvt_pk_bf16_f32 v18, v18, v18
    v_and_b32 v18, 0xffff0000, v18
    v_rcp_f32 v117, v18
    s_waitcnt vmcnt(21)
    s_mov_b32 s88, 0
TAGP_21:
    v_readfirstlane_b32 s14, v10
    v_readfirstlane_b32 s15, v11
    s_cmp_eq_u32 s15, 0
    s_cbranch_scc1 TAGR_23
    s_sub_u32 vcc_lo, s14, s86
    s_add_u32 vcc_lo, vcc_lo, 800
    s_cmp_lt_u32 vcc_lo, 0x40000000
    s_cbranch_scc1 TAGD_22
    s_cmp_ge_u32 s88, 24
    s_cbranch_scc1 TAGD_22
TAGR_23:
    s_add_u32 s88, s88, 1
    s_cmp_ge_u32 s88, 20000
    s_cbranch_scc1 TAGD_22
    s_sleep 2
    buffer_load_dwordx2 v[10:11], v12, s[56:59], 0 offen sc1
    s_waitcnt vmcnt(0)
    s_branch TAGP_21
TAGD_22:
    v_mov_b32 v118, s14
    v_mov_b32 v119, s15
    s_lshl_b32 s79, s10, 3
    v_add_u32 v16, s79, v3
    v_lshlrev_b32 v16, 4, v16
    s_lshl_b32 s79, s73, 10
    s_add_u32 s79, s79, 11534336
    v_cmp_eq_u32 vcc, 0, v4
    s_mov_b64 exec, vcc
    buffer_store_dwordx4 v[116:119], v16, s[36:39], s79 offen sc1
    s_mov_b64 exec, -1
    s_cmp_ge_u32 s74, 14
    s_cbranch_scc1 HEND_24
    s_waitcnt vmcnt(15)
    v_mov_b32 v16, 0
    v_mov_b32 v17, 0
    v_mov_b32 v18, 0
    v_mov_b32 v19, 0
    v_dot2_f32_bf16 v16, v60, v13, v16
    v_dot2_f32_bf16 v17, v61, v13, v17
    v_dot2_f32_bf16 v18, v62, v13, v18
    v_dot2_f32_bf16 v19, v63, v13, v19
    v_dot2_f32_bf16 v16, v64, v13, v16
    v_dot2_f32_bf16 v17, v65, v13, v17
    v_dot2_f32_bf16 v18, v66, v13, v18
    v_dot2_f32_bf16 v19, v67, v13, v19
    v_dot2_f32_bf16 v16, v68, v13, v16
    v_dot2_f32_bf16 v17, v69, v13, v17
    v_dot2_f32_bf16 v18, v70, v13, v18
    v_dot2_f32_bf16 v19, v71, v13, v19
    v_dot2_f32_bf16 v16, v72, v13, v16
    v_dot2_f32_bf16 v17, v73, v13, v17
    v_dot2_f32_bf16 v18, v74, v13, v18
    v_dot2_f32_bf16 v19, v75, v13, v19
    v_dot2_f32_bf16 v16, v76, v13, v16
    v_dot2_f32_bf16 v17, v77, v13, v17
    v_dot2_f32_bf16 v18, v78, v13, v18
    v_dot2_f32_bf16 v19, v79, v13, v19
    v_dot2_f32_bf16 v16, v80, v13, v16
    v_dot2_f32_bf16 v17, v81, v13, v17
    v_dot2_f32_bf16 v18, v82, v13, v18
    v_dot2_f32_bf16 v19, v83, v13, v19
    v_dot2_f32_bf16 v16, v84, v13, v16
    v_dot2_f32_bf16 v17, v85, v13, v17
    v_dot2_f32_bf16 v18, v86, v13, v18
    v_dot2_f32_bf16 v19, v87, v13, v19
    s_nop 2
    v_add_f32 v16, v16, v17
    v_add_f32 v18, v18, v19
    v_add_f32 v16, v16, v18
    s_nop 1
    v_add_f32_dpp v16, v16, v16 quad_perm:[1,0,3,2] row_mask:0xf bank_mask:0xf
    s_nop 1
    v_add_f32_dpp v16, v16, v16 quad_perm:[2,3,0,1] row_mask:0xf bank_mask:0xf
    s_nop 1
    v_add_f32_dpp v16, v16, v16 row_half_mirror row_mask:0xf bank_mask:0xf
    v_cvt_pk_bf16_f32 v120, v16, v16
    v_and_b32 v17, 0xffff0000, v120
    v_sub_f32 v16, v16, v17
    v_cvt_pk_bf16_f32 v18, v16, v16
    v_and_b32 v18, 0xffff0000, v18
    v_sub_f32 v16, v16, v18
    v_cvt_pk_bf16_f32 v121, v16, v16
    v_and_b32 v121, 0xffff, v121
    v_and_b32 v120, 0xffff, v120
    v_or_b32 v120, v120, v18
    v_mov_b32 v122, s14
    v_mov_b32 v123, s15
    s_lshl_b32 s79, s11, 3
    v_add_u32 v17, s79, v3
    v_lshrrev_b32 v18, 4, v17
    v_and_b32 v17, 15, v17
    v_lshlrev_b32 v17, 5, v17
    v_lshl_add_u32 v17, v18, 10, v17
    s_mul_i32 s79, s75, 10240
    s_lshl_b32 s78, s76, 4
    s_add_u32 s79, s79, s78
    s_add_u32 s79, s79, 11608064
    v_cmp_eq_u32 vcc, 0, v4
    s_mov_b64 exec, vcc
    buffer_store_dwordx4 v[120:123], v17, s[36:39], s79 offen sc1
    s_mov_b64 exec, -1
    s_lshl_b32 s79, s10, 3
    v_add_u32 v20, s79, v3
    v_lshlrev_b32 v20, 8, v20
    v_lshl_add_u32 v20, v4, 5, v20
    s_waitcnt vmcnt(9)
    v_mov_b32 v24, 0
    v_mov_b32 v25, 0
    v_mov_b32 v26, 0
    v_mov_b32 v27, 0
    v_mov_b32 v28, 0
    v_mov_b32 v29, 0
    v_mov_b32 v30, 0
    v_mov_b32 v31, 0
    v_dot2_f32_bf16 v24, v88, v14, v24
    v_dot2_f32_bf16 v25, v88, v15, v25
    v_dot2_f32_bf16 v26, v89, v14, v26
    v_dot2_f32_bf16 v27, v89, v15, v27
    v_dot2_f32_bf16 v28, v90, v14, v28
    v_dot2_f32_bf16 v29, v90, v15, v29
    v_dot2_f32_bf16 v30, v91, v14, v30
    v_dot2_f32_bf16 v31, v91, v15, v31
    v_dot2_f32_bf16 v24, v92, v14, v24
    v_dot2_f32_bf16 v25, v92, v15, v25
    v_dot2_f32_bf16 v26, v93, v14, v26
    v_dot2_f32_bf16 v27, v93, v15, v27
    v_dot2_f32_bf16 v28, v94, v14, v28
    v_dot2_f32_bf16 v29, v94, v15, v29
    v_dot2_f32_bf16 v30, v95, v14, v30
    v_dot2_f32_bf16 v31, v95, v15, v31
    v_dot2_f32_bf16 v24, v96, v14, v24
    v_dot2_f32_bf16 v25, v96, v15, v25
    v_dot2_f32_bf16 v26, v97, v14, v26
    v_dot2_f32_bf16 v27, v97, v15, v27
    v_dot2_f32_bf16 v28, v98, v14, v28
    v_dot2_f32_bf16 v29, v98, v15, v29
    v_dot2_f32_bf16 v30, v99, v14, v30
    v_dot2_f32_bf16 v31, v99, v15, v31
    v_dot2_f32_bf16 v24, v100, v14, v24
    v_dot2_f32_bf16 v25, v100, v15, v25
    v_dot2_f32_bf16 v26, v101, v14, v26
    v_dot2_f32_bf16 v27, v101, v15, v27
    v_dot2_f32_bf16 v28, v102, v14, v28
    v_dot2_f32_bf16 v29, v102, v15, v29
    v_dot2_f32_bf16 v30, v103, v14, v30
    v_dot2_f32_bf16 v31, v103, v15, v31
    v_dot2_f32_bf16 v24, v104, v14, v24
    v_dot2_f32_bf16 v25, v104, v15, v25
    v_dot2_f32_bf16 v26, v105, v14, v26
    v_dot2_f32_bf16 v27, v105, v15, v27
    v_dot2_f32_bf16 v28, v106, v14, v28
    v_dot2_f32_bf16 v29, v106, v15, v29
    v_dot2_f32_bf16 v30, v107, v14, v30
    v_dot2_f32_bf16 v31, v107, v15, v31
    v_dot2_f32_bf16 v24, v108, v14, v24
    v_dot2_f32_bf16 v25, v108, v15, v25
    v_dot2_f32_bf16 v26, v109, v14, v26
    v_dot2_f32_bf16 v27, v109, v15, v27
    v_dot2_f32_bf16 v28, v110, v14, v28
    v_dot2_f32_bf16 v29, v110, v15, v29
    v_dot2_f32_bf16 v30, v111, v14, v30
    v_dot2_f32_bf16 v31, v111, v15, v31
    v_dot2_f32_bf16 v24, v112, v14, v24
    v_dot2_f32_bf16 v25, v112, v15, v25
    v_dot2_f32_bf16 v26, v113, v14, v26
    v_dot2_f32_bf16 v27, v113, v15, v27
    v_dot2_f32_bf16 v28, v114, v14, v28
    v_dot2_f32_bf16 v29, v114, v15, v29
    v_dot2_f32_bf16 v30, v115, v14, v30
    v_dot2_f32_bf16 v31, v115, v15, v31
    s_nop 2
    ds_write_b128 v20, v[24:27] offset:0
    ds_write_b128 v20, v[28:31] offset:16
    s_waitcnt lgkmcnt(0)
    s_barrier
    s_lshr_b32 s79, s10, 1
    s_cmp_lg_u32 s79, 0
    s_cbranch_scc1 HSK_25
    s_and_b32 s79, s10, 1
    s_lshl_b32 s78, s79, 13
    v_lshl_add_u32 v21, v1, 2, s78
    ds_read_b32 v32, v21 offset:0
    ds_read_b32 v33, v21 offset:256
    ds_read_b32 v34, v21 offset:512
    ds_read_b32 v35, v21 offset:768
    ds_read_b32 v36, v21 offset:1024
    ds_read_b32 v37, v21 offset:1280
    ds_read_b32 v38, v21 offset:1536
    ds_read_b32 v39, v21 offset:1792
    ds_read_b32 v40, v21 offset:2048
    ds_read_b32 v41, v21 offset:2304
    ds_read_b32 v42, v21 offset:2560
    ds_read_b32 v43, v21 offset:2816
    ds_read_b32 v44, v21 offset:3072
    ds_read_b32 v45, v21 offset:3328
    ds_read_b32 v46, v21 offset:3584
    s_waitcnt lgkmcnt(0)
    ds_read_b32 v47, v21 offset:3840
    ds_read_b32 v48, v21 offset:4096
    ds_read_b32 v49, v21 offset:4352
    ds_read_b32 v50, v21 offset:4608
    ds_read_b32 v51, v21 offset:4864
    ds_read_b32 v52, v21 offset:5120
    ds_read_b32 v53, v21 offset:5376
    ds_read_b32 v54, v21 offset:5632
    ds_read_b32 v55, v21 offset:5888
    ds_read_b32 v56, v21 offset:6144
    ds_read_b32 v57, v21 offset:6400
    ds_read_b32 v58, v21 offset:6656
    ds_read_b32 v59, v21 offset:6912
    ds_read_b32 v60, v21 offset:7168
    ds_read_b32 v61, v21 offset:7424
    ds_read_b32 v62, v21 offset:7680
    s_waitcnt lgkmcnt(0)
    ds_read_b32 v63, v21 offset:7936
    s_waitcnt lgkmcnt(0)
    v_add_f32 v32, v32, v48
    v_add_f32 v33, v33, v49
    v_add_f32 v34, v34, v50
    v_add_f32 v35, v35, v51
    v_add_f32 v36, v36, v52
    v_add_f32 v37, v37, v53
    v_add_f32 v38, v38, v54
    v_add_f32 v39, v39, v55
    v_add_f32 v40, v40, v56
    v_add_f32 v41, v41, v57
    v_add_f32 v42, v42, v58
    v_add_f32 v43, v43, v59
    v_add_f32 v44, v44, v60
    v_add_f32 v45, v45, v61
    v_add_f32 v46, v46, v62
    v_add_f32 v47, v47, v63
    v_add_f32 v32, v32, v40
    v_add_f32 v33, v33, v41
    v_add_f32 v34, v34, v42
    v_add_f32 v35, v35, v43
    v_add_f32 v36, v36, v44
    v_add_f32 v37, v37, v45
    v_add_f32 v38, v38, v46
    v_add_f32 v39, v39, v47
    v_add_f32 v32, v32, v36
    v_add_f32 v33, v33, v37
    v_add_f32 v34, v34, v38
    v_add_f32 v35, v35, v39
    v_add_f32 v32, v32, v34
    v_add_f32 v33, v33, v35
    v_add_f32 v32, v32, v33
    v_cvt_pk_bf16_f32 v124, v32, v32
    v_and_b32 v33, 0xffff0000, v124
    v_sub_f32 v32, v32, v33
    v_cvt_pk_bf16_f32 v34, v32, v32
    v_and_b32 v34, 0xffff0000, v34
    v_sub_f32 v32, v32, v34
    v_cvt_pk_bf16_f32 v125, v32, v32
    v_and_b32 v125, 0xffff, v125
    v_and_b32 v124, 0xffff, v124
    v_or_b32 v124, v124, v34
    v_mov_b32 v126, s14
    v_mov_b32 v127, s15
    v_and_b32 v33, 3, v1
    v_bfe_u32 v34, v1, 2, 1
    v_bfe_u32 v35, v1, 3, 1
    v_lshl_or_b32 v33, v34, 3, v33
    v_lshl_or_b32 v33, v35, 2, v33
    v_lshlrev_b32 v33, 4, v33
    v_lshrrev_b32 v34, 4, v1
    v_lshl_add_u32 v33, v34, 10, v33
    s_lshl_b32 s79, s79, 8
    s_mul_i32 s78, s75, 10240
    s_add_u32 s79, s79, s78
    s_lshl_b32 s78, s76, 9
    s_add_u32 s79, s79, s78
    s_add_u32 s79, s79, 11599872
    buffer_store_dwordx4 v[124:127], v33, s[36:39], s79 offen sc1
HSK_25:
    s_waitcnt vmcnt(2)
    v_accvgpr_read_b32 v88, a0
    v_accvgpr_read_b32 v89, a1
    v_accvgpr_read_b32 v90, a2
    v_accvgpr_read_b32 v91, a3
    v_accvgpr_read_b32 v92, a4
    v_accvgpr_read_b32 v93, a5
    v_accvgpr_read_b32 v94, a6
    v_accvgpr_read_b32 v95, a7
    v_accvgpr_read_b32 v96, a8
    v_accvgpr_read_b32 v97, a9
    v_accvgpr_read_b32 v98, a10
    v_accvgpr_read_b32 v99, a11
    v_accvgpr_read_b32 v100, a12
    v_accvgpr_read_b32 v101, a13
    v_accvgpr_read_b32 v102, a14
    v_accvgpr_read_b32 v103, a15
    v_accvgpr_read_b32 v104, a16
    v_accvgpr_read_b32 v105, a17
    v_accvgpr_read_b32 v106, a18
    v_accvgpr_read_b32 v107, a19
    v_accvgpr_read_b32 v108, a20
    v_accvgpr_read_b32 v109, a21
    v_accvgpr_read_b32 v110, a22
    v_accvgpr_read_b32 v111, a23
    v_accvgpr_read_b32 v112, a24
    v_accvgpr_read_b32 v113, a25
    v_accvgpr_read_b32 v114, a26
    v_accvgpr_read_b32 v115, a27
    v_mov_b32 v24, 0
    v_mov_b32 v25, 0
    v_mov_b32 v26, 0
    v_mov_b32 v27, 0
    v_mov_b32 v28, 0
    v_mov_b32 v29, 0
    v_mov_b32 v30, 0
    v_mov_b32 v31, 0
    v_dot2_f32_bf16 v24, v88, v14, v24
    v_dot2_f32_bf16 v25, v88, v15, v25
    v_dot2_f32_bf16 v26, v89, v14, v26
    v_dot2_f32_bf16 v27, v89, v15, v27
    v_dot2_f32_bf16 v28, v90, v14, v28
    v_dot2_f32_bf16 v29, v90, v15, v29
    v_dot2_f32_bf16 v30, v91, v14, v30
    v_dot2_f32_bf16 v31, v91, v15, v31
    v_dot2_f32_bf16 v24, v92, v14, v24
    v_dot2_f32_bf16 v25, v92, v15, v25
    v_dot2_f32_bf16 v26, v93, v14, v26
    v_dot2_f32_bf16 v27, v93, v15, v27
    v_dot2_f32_bf16 v28, v94, v14, v28
    v_dot2_f32_bf16 v29, v94, v15, v29
    v_dot2_f32_bf16 v30, v95, v14, v30
    v_dot2_f32_bf16 v31, v95, v15, v31
    v_dot2_f32_bf16 v24, v96, v14, v24
    v_dot2_f32_bf16 v25, v96, v15, v25
    v_dot2_f32_bf16 v26, v97, v14, v26
    v_dot2_f32_bf16 v27, v97, v15, v27
    v_dot2_f32_bf16 v28, v98, v14, v28
    v_dot2_f32_bf16 v29, v98, v15, v29
    v_dot2_f32_bf16 v30, v99, v14, v30
    v_dot2_f32_bf16 v31, v99, v15, v31
    v_dot2_f32_bf16 v24, v100, v14, v24
    v_dot2_f32_bf16 v25, v100, v15, v25
    v_dot2_f32_bf16 v26, v101, v14, v26
    v_dot2_f32_bf16 v27, v101, v15, v27
    v_dot2_f32_bf16 v28, v102, v14, v28
    v_dot2_f32_bf16 v29, v102, v15, v29
    v_dot2_f32_bf16 v30, v103, v14, v30
    v_dot2_f32_bf16 v31, v103, v15, v31
    v_dot2_f32_bf16 v24, v104, v14, v24
    v_dot2_f32_bf16 v25, v104, v15, v25
    v_dot2_f32_bf16 v26, v105, v14, v26
    v_dot2_f32_bf16 v27, v105, v15, v27
    v_dot2_f32_bf16 v28, v106, v14, v28
    v_dot2_f32_bf16 v29, v106, v15, v29
    v_dot2_f32_bf16 v30, v107, v14, v30
    v_dot2_f32_bf16 v31, v107, v15, v31
    v_dot2_f32_bf16 v24, v108, v14, v24
    v_dot2_f32_bf16 v25, v108, v15, v25
    v_dot2_f32_bf16 v26, v109, v14, v26
    v_dot2_f32_bf16 v27, v109, v15, v27
    v_dot2_f32_bf16 v28, v110, v14, v28
    v_dot2_f32_bf16 v29, v110, v15, v29
    v_dot2_f32_bf16 v30, v111, v14, v30
    v_dot2_f32_bf16 v31, v111, v15, v31
    v_dot2_f32_bf16 v24, v112, v14, v24
    v_dot2_f32_bf16 v25, v112, v15, v25
    v_dot2_f32_bf16 v26, v113, v14, v26
    v_dot2_f32_bf16 v27, v113, v15, v27
    v_dot2_f32_bf16 v28, v114, v14, v28
    v_dot2_f32_bf16 v29, v114, v15, v29
    v_dot2_f32_bf16 v30, v115, v14, v30
    v_dot2_f32_bf16 v31, v115, v15, v31
    s_nop 2
    ds_write_b128 v20, v[24:27] offset:16384
    ds_write_b128 v20, v[28:31] offset:16400
    s_waitcnt lgkmcnt(0)
    s_barrier
    s_lshr_b32 s79, s10, 1
    s_cmp_lg_u32 s79, 1
    s_cbranch_scc1 HSK_26
    s_and_b32 s79, s10, 1
    s_lshl_b32 s78, s79, 13
    v_lshl_add_u32 v21, v1, 2, s78
    ds_read_b32 v32, v21 offset:16384
    ds_read_b32 v33, v21 offset:16640
    ds_read_b32 v34, v21 offset:16896
    ds_read_b32 v35, v21 offset:17152
    ds_read_b32 v36, v21 offset:17408
    ds_read_b32 v37, v21 offset:17664
    ds_read_b32 v38, v21 offset:17920
    ds_read_b32 v39, v21 offset:18176
    ds_read_b32 v40, v21 offset:18432
    ds_read_b32 v41, v21 offset:18688
    ds_read_b32 v42, v21 offset:18944
    ds_read_b32 v43, v21 offset:19200
    ds_read_b32 v44, v21 offset:19456
    ds_read_b32 v45, v21 offset:19712
    ds_read_b32 v46, v21 offset:19968
    s_waitcnt lgkmcnt(0)
    ds_read_b32 v47, v21 offset:20224
    ds_read_b32 v48, v21 offset:20480
    ds_read_b32 v49, v21 offset:20736
    ds_read_b32 v50, v21 offset:20992
    ds_read_b32 v51, v21 offset:21248
    ds_read_b32 v52, v21 offset:21504
    ds_read_b32 v53, v21 offset:21760
    ds_read_b32 v54, v21 offset:22016
    ds_read_b32 v55, v21 offset:22272
    ds_read_b32 v56, v21 offset:22528
    ds_read_b32 v57, v21 offset:22784
    ds_read_b32 v58, v21 offset:23040
    ds_read_b32 v59, v21 offset:23296
    ds_read_b32 v60, v21 offset:23552
    ds_read_b32 v61, v21 offset:23808
    ds_read_b32 v62, v21 offset:24064
    s_waitcnt lgkmcnt(0)
    ds_read_b32 v63, v21 offset:24320
    s_waitcnt lgkmcnt(0)
    v_add_f32 v32, v32, v48
    v_add_f32 v33, v33, v49
    v_add_f32 v34, v34, v50
    v_add_f32 v35, v35, v51
    v_add_f32 v36, v36, v52
    v_add_f32 v37, v37, v53
    v_add_f32 v38, v38, v54
    v_add_f32 v39, v39, v55
    v_add_f32 v40, v40, v56
    v_add_f32 v41, v41, v57
    v_add_f32 v42, v42, v58
    v_add_f32 v43, v43, v59
    v_add_f32 v44, v44, v60
    v_add_f32 v45, v45, v61
    v_add_f32 v46, v46, v62
    v_add_f32 v47, v47, v63
    v_add_f32 v32, v32, v40
    v_add_f32 v33, v33, v41
    v_add_f32 v34, v34, v42
    v_add_f32 v35, v35, v43
    v_add_f32 v36, v36, v44
    v_add_f32 v37, v37, v45
    v_add_f32 v38, v38, v46
    v_add_f32 v39, v39, v47
    v_add_f32 v32, v32, v36
    v_add_f32 v33, v33, v37
    v_add_f32 v34, v34, v38
    v_add_f32 v35, v35, v39
    v_add_f32 v32, v32, v34
    v_add_f32 v33, v33, v35
    v_add_f32 v32, v32, v33
    v_cvt_pk_bf16_f32 v124, v32, v32
    v_and_b32 v33, 0xffff0000, v124
    v_sub_f32 v32, v32, v33
    v_cvt_pk_bf16_f32 v34, v32, v32
    v_and_b32 v34, 0xffff0000, v34
    v_sub_f32 v32, v32, v34
    v_cvt_pk_bf16_f32 v125, v32, v32
    v_and_b32 v125, 0xffff, v125
    v_and_b32 v124, 0xffff, v124
    v_or_b32 v124, v124, v34
    v_mov_b32 v126, s14
    v_mov_b32 v127, s15
    v_and_b32 v33, 3, v1
    v_bfe_u32 v34, v1, 2, 1
    v_bfe_u32 v35, v1, 3, 1
    v_lshl_or_b32 v33, v34, 3, v33
    v_lshl_or_b32 v33, v35, 2, v33
    v_lshlrev_b32 v33, 4, v33
    v_lshrrev_b32 v34, 4, v1
    v_lshl_add_u32 v33, v34, 10, v33
    s_lshl_b32 s79, s79, 8
    s_mul_i32 s78, s75, 10240
    s_add_u32 s79, s79, s78
    s_lshl_b32 s78, s76, 9
    s_add_u32 s79, s79, s78
    s_add_u32 s79, s79, 11603968
    buffer_store_dwordx4 v[124:127], v33, s[36:39], s79 offen sc1
HSK_26:
HEND_24:
    s_waitcnt vmcnt(0)
    s_barrier
    s_lshl_b32 s77, s72, 3
    s_add_u32 s77, s77, s10
    v_lshlrev_b32 v5, 7, v1
    s_lshr_b32 s78, s77, 1
    s_min_u32 s78, s78, 13
    s_lshl_b32 s78, s78, 7
    s_and_b32 s79, s77, 1
    s_lshl_b32 s79, s79, 5
    s_add_u32 s78, s78, s79
    s_mul_i32 s78, s78, 896
    s_and_b32 s79, s77, 15
    s_mul_i32 s79, s79, 25088
    s_cmp_lt_u32 s77, 16
    s_cselect_b32 s92, s44, s48
    s_cselect_b32 s93, s45, s49
    s_mov_b32 s94, 401408
    s_mov_b32 s95, 0x20000
    s_add_u32 s76, s78, 0
    buffer_load_dword v16, v5, s[40:43], s76 offen
    s_add_u32 s76, s78, 8192
    buffer_load_dword v17, v5, s[40:43], s76 offen
    s_add_u32 s76, s78, 16384
    buffer_load_dword v18, v5, s[40:43], s76 offen
    s_add_u32 s76, s78, 24576
    buffer_load_dword v19, v5, s[40:43], s76 offen
    buffer_load_dword v16, v5, s[92:95], s79 offen
    s_add_u32 s79, s79, 8192
    buffer_load_dword v17, v5, s[92:95], s79 offen
    s_add_u32 s79, s79, 8192
    buffer_load_dword v18, v5, s[92:95], s79 offen
    s_add_u32 s79, s79, 8192
    buffer_load_dword v19, v5, s[92:95], s79 offen
    s_add_u32 s79, s79, 8192
    s_add_u32 s76, s78, 57344
    buffer_load_dword v16, v5, s[40:43], s76 offen
    s_add_u32 s76, s78, 65536
    buffer_load_dword v17, v5, s[40:43], s76 offen
    s_add_u32 s76, s78, 73728
    buffer_load_dword v18, v5, s[40:43], s76 offen
    s_add_u32 s76, s78, 81920
    buffer_load_dword v19, v5, s[40:43], s76 offen
    s_waitcnt vmcnt(0)
    s_branch L_END
L_END:
    s_endpgm
L_CODE_END:
.section .rodata,"a"
.p2align 6
.amdhsa_kernel recurrent_scan__ssm_conv_s5__swiglu_ffn__prompt_kernel
  .amdhsa_next_free_vgpr 256
  .amdhsa_next_free_sgpr 102
  .amdhsa_accum_offset 192
  .amdhsa_group_segment_fixed_size 0
  .amdhsa_kernarg_size 128
  .amdhsa_user_sgpr_count 2
  .amdhsa_user_sgpr_kernarg_segment_ptr 1
  .amdhsa_system_sgpr_workgroup_id_x 1
.end_amdhsa_kernel
```
